```python
import torch

def _softmax(x, axis=-1):
    return torch.softmax(x, dim=axis)
def _gelu(x):
    return torch.nn.functional.gelu(x, approximate="tanh")
def _silu(x):
    return torch.nn.functional.silu(x)
def _sigmoid(x):
    return torch.sigmoid(x)
def _layernorm(x, axis=-1, eps=1e-5):
    m = x.mean(dim=axis, keepdim=True)
    v = x.var(dim=axis, keepdim=True, unbiased=False)
    return (x - m) / torch.sqrt(v + eps)
def _scatter_add(tgt, idx, src, axis=0):
    return tgt.clone().index_add_(axis, idx, src)
def _segment_sum(src, seg, n):
    out = torch.zeros((n,) + src.shape[1:], dtype=src.dtype)
    return out.index_add_(0, seg, src)
def _pad(x, pw):
    flat = tuple(v for pair in reversed(pw) for v in pair)
    return torch.nn.functional.pad(x, flat)

kernel_name = 'standalone__glu_gated_geglu__prompt'

def setup_inputs():

    _w = (lambda a: (lambda t: t.to(torch.bfloat16) if t.is_floating_point() else t)(torch.as_tensor(a)))
    B, S, Dm, Df = 1, 2048, 512, 1792
    return {
        "x": _w((lambda *s: torch.randn(*s, dtype=torch.bfloat16) * 0.05)(B, S, Dm)),
        "w_gate": _w((lambda *s: torch.randn(*s, dtype=torch.bfloat16) * 0.05)(Dm, Df) * (Dm ** -0.5)),
        "w_up": _w((lambda *s: torch.randn(*s, dtype=torch.bfloat16) * 0.05)(Dm, Df) * (Dm ** -0.5)),
        "w_down": _w((lambda *s: torch.randn(*s, dtype=torch.bfloat16) * 0.05)(Df, Dm) * (Df ** -0.5)),
    }

def reference(x, w_gate, w_up, w_down):
    g = torch.einsum("bsd,df->bsf", x, w_gate)
    u = torch.einsum("bsd,df->bsf", x, w_up)
    h = _gelu(g) * u
    return torch.einsum("bsf,fd->bsd", h, w_down)
```

```asm
; @launch grid=(256,1,1) block=(256,1,1) lds=163840
.amdgcn_target "amdgcn-amd-amdhsa--gfx950"
.text
.globl standalone__glu_gated_geglu__prompt_kernel
.p2align 8
.type standalone__glu_gated_geglu__prompt_kernel,@function
standalone__glu_gated_geglu__prompt_kernel:
    s_load_dwordx8 s[4:11], s[0:1], 0
    s_load_dwordx4 s[12:15], s[0:1], 32
    s_load_dwordx2 s[16:17], s[0:1], 48
    s_cmp_ge_u32 s2, 256
    s_cbranch_scc1 END0
    v_lshrrev_b32 v1, 6, v0
    v_and_b32 v2, 63, v0
    v_readfirstlane_b32 s18, v1
    s_and_b32 s3, s2, 7
    s_lshr_b32 s46, s2, 3
    s_and_b32 s23, s46, 3
    s_lshl2_add_u32 s21, s3, s23
    s_lshr_b32 s23, s46, 2
    s_add_u32 s23, s23, 4
    s_and_b32 s22, s23, 7
    v_lshrrev_b32 v3, 3, v2
    v_and_b32 v4, 7, v2
    v_lshrrev_b32 v5, 4, v2
    s_mul_i32 s43, s18, 24576
    s_cmp_lt_u32 s46, 28
    s_cbranch_scc1 MAIN
    s_getpc_b64 s[50:51]
PCREF:
    s_sub_u32 s50, s50, PCREF-standalone__glu_gated_geglu__prompt_kernel
    s_subb_u32 s51, s51, 0
    s_sub_u32 s23, s46, 28
    s_lshl_b32 s23, s23, 13
    v_lshl_add_u32 v12, v2, 7, s23
    v_min_u32 v12, CODE_END-4-standalone__glu_gated_geglu__prompt_kernel, v12
    s_cmp_lg_u32 s18, 0
    s_cbranch_scc1 H_NOCPF
    global_load_dword v13, v12, s[50:51]
H_NOCPF:
    s_sub_u32 s40, s46, 28
    s_lshl2_add_u32 s40, s40, s18
    s_and_b32 s41, s3, 3
    s_lshr_b32 s42, s3, 2
    v_min_u32 v8, 6, v4
    v_lshlrev_b32 v8, 8, v8
    v_mul_u32_u24 v10, 3584, v3
    v_add_u32 v10, v10, v8
    v_lshlrev_b32 v8, 10, v2
    s_and_b32 s23, s40, 1
    s_lshl1_add_u32 s23, s41, s23
    s_mul_i32 s59, s23, 28672
    s_mul_i32 s23, s42, 1792
    s_add_u32 s59, s59, s23
    s_lshr_b32 s23, s40, 3
    s_add_u32 s23, s23, 2
    s_mul_i32 s44, s23, 229376
    s_add_u32 s44, s44, s59
    s_lshl1_add_u32 s57, s41, s42
    s_and_b32 s55, s40, 3
    s_lshl2_add_u32 s57, s57, s55
    s_lshl_b32 s57, s57, 16
    s_lshl_b32 s23, s23, 7
    s_add_u32 s57, s57, s23
    s_mov_b32 s27, 0x20000
    s_mov_b32 s31, 0x20000
    s_mov_b32 s30, 1835008
    s_mov_b32 s58, 458752
    s_bitcmp0_b32 s40, 2
    s_cselect_b32 s44, s57, s44
    s_cselect_b32 s58, 256, s58
    s_cselect_b32 s26, 2097152, s30
    s_cselect_b64 vcc, -1, 0
    s_nop 1
    v_cndmask_b32 v8, v10, v8, vcc
    s_waitcnt lgkmcnt(0)
    s_cmp_eq_u32 s2, 255
    s_cbranch_scc1 CLEAR
CLEARED:
    s_bitcmp0_b32 s40, 1
    s_cselect_b32 s28, s6, s8
    s_cselect_b32 s29, s7, s9
    s_and_b32 s29, s29, 0xffff
    s_bitcmp0_b32 s40, 2
    s_cselect_b32 s24, s4, s28
    s_cselect_b32 s25, s5, s29
    s_and_b32 s25, s25, 0xffff
    buffer_load_dword v9, v8, s[24:27], s44 offen
    s_add_u32 s44, s44, s58
    buffer_load_dword v9, v8, s[24:27], s44 offen
    s_add_u32 s44, s44, s58
    buffer_load_dword v9, v8, s[24:27], s44 offen
    s_add_u32 s44, s44, s58
    s_lshr_b32 s23, s40, 2
    s_add_u32 s57, s23, 4
    s_mul_i32 s57, s57, 229376
    s_add_u32 s58, s59, s57
    s_sub_u32 s23, s23, 0
    s_and_b32 s23, s23, 7
    s_mul_i32 s23, s23, 229376
    s_add_u32 s59, s59, s23
    s_min_u32 s23, s40, 13
    s_sub_u32 s57, s23, 7
    s_cselect_b32 s23, s23, s57
    s_cselect_b32 s45, 0, 16384
    s_mul_i32 s57, s3, 7
    s_add_u32 s23, s23, s57
    s_lshr_b32 s57, s23, 2
    s_lshl_b32 s57, s57, 17
    s_add_u32 s45, s45, s57
    s_and_b32 s57, s23, 2
    s_lshl_b32 s57, s57, 14
    s_add_u32 s45, s45, s57
    s_and_b32 s57, s23, 1
    s_lshl_b32 s57, s57, 13
    s_add_u32 s45, s45, s57
    v_lshlrev_b32 v11, 7, v2
    s_mov_b32 s24, s10
    s_and_b32 s25, s11, 0xffff
    s_mov_b32 s26, 1835008
    s_mov_b32 s27, 0x20000
    buffer_load_dword v9, v10, s[28:31], s59 offen offset:128
    buffer_load_dword v9, v11, s[24:27], s45 offen
    s_add_u32 s45, s45, 65536
    buffer_load_dword v9, v10, s[28:31], s58 offen offset:128
    buffer_load_dword v9, v11, s[24:27], s45 offen
    s_add_u32 s45, s45, 65536
    s_branch HELPER
END0:
    s_endpgm
MAIN:
    s_and_b32 s19, s3, 3
    s_lshl_b32 s19, s19, 2
    s_and_b32 s23, s46, 3
    s_add_u32 s19, s19, s23
    s_lshr_b32 s47, s3, 2
    s_mul_i32 s47, s47, 7
    s_lshr_b32 s57, s46, 2
    s_add_u32 s47, s47, s57
    s_add_u32 s23, s23, s57
    s_bitcmp1_b32 s23, 0
    s_mov_b32 s48, 0x76534210
    s_mov_b32 s49, 0x75643120
    s_cselect_b32 s48, 0x76453201, s48
    s_cselect_b32 s49, 0x67542301, s49
    s_bitcmp1_b32 s23, 1
    s_cselect_b32 s48, s49, s48
    v_xor_b32 v6, v5, v4
    v_lshlrev_b32 v6, 4, v6
    v_lshl_add_u32 v216, v3, 10, v6
    v_xor_b32 v6, 64, v216
    v_add_u32 v217, 7168, v6
    v_add_u32 v218, 14336, v216
    v_add_u32 v219, 21504, v6
    s_and_b32 s23, s18, 1
    s_lshl_b32 s23, s23, 1
    v_and_b32 v6, 1, v5
    v_or_b32 v6, s23, v6
    v_lshlrev_b32 v6, 1, v6
    v_xor_b32 v6, v6, v4
    v_lshlrev_b32 v6, 4, v6
    v_mul_u32_u24 v7, 3584, v3
    v_add_u32 v220, v6, v7
    s_lshl_b32 s20, s19, 17
    s_lshl_b32 s23, s18, 15
    s_add_u32 s20, s20, s23
    s_lshl_b32 s58, s18, 12
    s_and_b32 s23, s18, 1
    s_mul_i32 s59, s23, 28672
    s_lshl_b32 s57, s47, 8
    s_add_u32 s59, s59, s57
    s_bfe_u32 s49, s48, 0x40000
    s_mul_i32 s42, s49, 229376
    s_add_u32 s42, s42, s59
    s_lshl_b32 s49, s49, 7
    s_add_u32 s40, s49, s20
    s_lshl_b32 s44, s23, 10
    s_lshr_b32 s23, s18, 1
    s_lshl_b32 s23, s23, 13
    s_add_u32 s44, s44, s23
    s_add_u32 s44, s44, 98304
    s_mov_b32 s26, 2097152
    s_mov_b32 s27, 0x20000
    s_mov_b32 s30, 1835008
    s_mov_b32 s31, 0x20000
    s_cmp_lt_u32 s18, 2
    s_waitcnt lgkmcnt(0)
    s_cselect_b32 s28, s6, s8
    s_cselect_b32 s29, s7, s9
    s_and_b32 s29, s29, 0xffff
    s_mov_b32 s24, s4
    s_and_b32 s25, s5, 0xffff
    s_add_u32 m0, s44, 0
    s_nop 0
    buffer_load_dwordx4 v220, s[28:31], s42 offen lds
    s_add_u32 s42, s42, 57344
    s_add_u32 m0, s44, 2048
    s_nop 0
    buffer_load_dwordx4 v220, s[28:31], s42 offen lds
    s_add_u32 s42, s42, 57344
    s_add_u32 m0, s44, 4096
    s_nop 0
    buffer_load_dwordx4 v220, s[28:31], s42 offen lds
    s_add_u32 s42, s42, 57344
    s_add_u32 m0, s44, 6144
    s_nop 0
    buffer_load_dwordx4 v220, s[28:31], s42 offen lds
    s_add_u32 m0, s58, 0
    s_nop 0
    buffer_load_dwordx4 v216, s[24:27], s40 offen offset:0 lds
    buffer_load_dwordx4 v217, s[24:27], s40 offen offset:1024 lds
    buffer_load_dwordx4 v218, s[24:27], s40 offen offset:2048 lds
    buffer_load_dwordx4 v219, s[24:27], s40 offen offset:3072 lds
    s_bfe_u32 s49, s48, 0x40004
    s_mul_i32 s42, s49, 229376
    s_add_u32 s42, s42, s59
    s_lshl_b32 s49, s49, 7
    s_add_u32 s40, s49, s20
    v_and_b32 v6, 15, v2
    v_bfe_u32 v8, v6, 1, 3
    v_xor_b32 v8, v8, v5
    v_lshlrev_b32 v8, 4, v8
    v_lshl_add_u32 v8, v6, 7, v8
    s_and_b32 s23, s18, 1
    s_lshl_b32 s23, s23, 13
    v_add_u32 v208, s23, v8
    v_xor_b32 v209, 64, v208
    v_add_u32 v210, 49152, v208
    v_add_u32 v211, 49152, v209
    v_bfe_u32 v6, v2, 4, 1
    v_bfe_u32 v8, v2, 2, 2
    v_lshl_add_u32 v9, v5, 3, v8
    v_lshlrev_b32 v9, 7, v9
    v_bfe_u32 v8, v2, 3, 1
    v_lshl_add_u32 v8, v6, 1, v8
    v_lshl_add_u32 v9, v8, 5, v9
    v_and_b32 v8, 3, v2
    v_lshl_add_u32 v9, v8, 3, v9
    v_add_u32 v9, 98304, v9
    s_and_b32 s23, s18, 2
    s_lshl_b32 s23, s23, 5
    v_xor_b32 v212, s23, v9
    v_xor_b32 v213, 32, v212
    v_mov_b32 v222, 0xc0135761
    v_mov_b32 v224, 0xbdd2d3e8
    v_mov_b32 v223, 0xc0135761
    v_mov_b32 v225, 0xbdd2d3e8
    s_and_b32 s23, s18, 1
    s_lshl1_add_u32 s0, s19, s23
    s_lshr_b32 s23, s18, 1
    s_lshl1_add_u32 s57, s47, s23
    s_mul_i32 s57, s57, 37
    s_lshr_b32 s57, s57, 8
    s_lshl2_add_u32 s57, s0, s57
    s_lshl_b32 s57, s57, 12
    s_add_u32 s50, s57, 14680064
    v_mov_b32 v237, 0x1
    v_mov_b32 v238, 0x10000
    v_mov_b32 v239, 0x1000000
    s_lshl2_add_u32 s23, s47, s23
    s_lshl_b32 s23, s23, 15
    s_lshr_b32 s57, s0, 2
    s_mul_i32 s57, s57, 1835008
    s_add_u32 s23, s23, s57
    s_and_b32 s57, s0, 3
    s_lshl_b32 s57, s57, 13
    s_add_u32 s0, s23, s57
    s_cmp_eq_u32 s18, 0
    s_cbranch_scc1 PAD0
PADRET0:
    s_add_u32 m0, s44, 16384
    s_nop 0
    buffer_load_dwordx4 v220, s[28:31], s42 offen lds
    s_add_u32 s42, s42, 57344
    s_add_u32 m0, s44, 18432
    s_nop 0
    buffer_load_dwordx4 v220, s[28:31], s42 offen lds
    s_add_u32 s42, s42, 57344
    s_add_u32 m0, s44, 20480
    s_nop 0
    buffer_load_dwordx4 v220, s[28:31], s42 offen lds
    s_add_u32 s42, s42, 57344
    s_add_u32 m0, s44, 22528
    s_nop 0
    buffer_load_dwordx4 v220, s[28:31], s42 offen lds
    s_add_u32 m0, s58, 24576
    s_nop 0
    buffer_load_dwordx4 v216, s[24:27], s40 offen offset:0 lds
    buffer_load_dwordx4 v217, s[24:27], s40 offen offset:1024 lds
    buffer_load_dwordx4 v218, s[24:27], s40 offen offset:2048 lds
    buffer_load_dwordx4 v219, s[24:27], s40 offen offset:3072 lds
    s_waitcnt vmcnt(8)
    s_barrier
    ds_read_b128 a[0:3], v208 offset:0
    ds_read_b64_tr_b16 v[144:145], v212 offset:0
    ds_read_b64_tr_b16 v[146:147], v212 offset:512
    ds_read_b128 a[4:7], v208 offset:2048
    ds_read_b128 a[8:11], v208 offset:4096
    ds_read_b128 a[12:15], v208 offset:6144
    ds_read_b64_tr_b16 v[148:149], v212 offset:8192
    ds_read_b64_tr_b16 v[150:151], v212 offset:8704
    ds_read_b64_tr_b16 v[152:153], v213 offset:0
    ds_read_b64_tr_b16 v[154:155], v213 offset:512
    s_waitcnt lgkmcnt(7)
    v_mfma_f32_16x16x32_bf16 v[16:19], v[144:147], a[0:3], 0
    s_waitcnt lgkmcnt(6)
    ds_read_b64_tr_b16 v[156:157], v213 offset:8192
    s_bfe_u32 s49, s48, 0x40008
    v_mfma_f32_16x16x32_bf16 v[32:35], v[144:147], a[4:7], 0
    s_waitcnt lgkmcnt(6)
    ds_read_b64_tr_b16 v[158:159], v213 offset:8704
    s_mul_i32 s42, s49, 229376
    v_mfma_f32_16x16x32_bf16 v[48:51], v[144:147], a[8:11], 0
    s_waitcnt lgkmcnt(6)
    ds_read_b128 a[16:19], v209 offset:0
    s_add_u32 s42, s42, s59
    v_mfma_f32_16x16x32_bf16 v[64:67], v[144:147], a[12:15], 0
    s_waitcnt lgkmcnt(5)
    ds_read_b64_tr_b16 v[160:161], v212 offset:4096
    s_lshl_b32 s49, s49, 7
    v_mfma_f32_16x16x32_bf16 v[24:27], v[148:151], a[0:3], 0
    s_add_u32 s40, s49, s20
    ds_read_b64_tr_b16 v[162:163], v212 offset:4608
    s_add_u32 m0, s44, 32768
    v_mfma_f32_16x16x32_bf16 v[40:43], v[148:151], a[4:7], 0
    ds_read_b128 a[20:23], v209 offset:2048
    buffer_load_dwordx4 v220, s[28:31], s42 offen lds
    v_mfma_f32_16x16x32_bf16 v[56:59], v[148:151], a[8:11], 0
    s_add_u32 s42, s42, 57344
    ds_read_b128 a[24:27], v209 offset:4096
    s_add_u32 m0, s44, 34816
    v_mfma_f32_16x16x32_bf16 v[72:75], v[148:151], a[12:15], 0
    s_waitcnt lgkmcnt(7)
    ds_read_b128 a[28:31], v209 offset:6144
    buffer_load_dwordx4 v220, s[28:31], s42 offen lds
    v_mfma_f32_16x16x32_bf16 v[20:23], v[152:155], a[0:3], 0
    s_add_u32 s42, s42, 57344
    ds_read_b64_tr_b16 v[164:165], v212 offset:12288
    s_add_u32 m0, s44, 36864
    v_mfma_f32_16x16x32_bf16 v[36:39], v[152:155], a[4:7], 0
    ds_read_b64_tr_b16 v[166:167], v212 offset:12800
    buffer_load_dwordx4 v220, s[28:31], s42 offen lds
    v_mfma_f32_16x16x32_bf16 v[52:55], v[152:155], a[8:11], 0
    s_add_u32 s42, s42, 57344
    ds_read_b64_tr_b16 v[168:169], v213 offset:4096
    s_add_u32 m0, s44, 38912
    v_mfma_f32_16x16x32_bf16 v[68:71], v[152:155], a[12:15], 0
    s_waitcnt lgkmcnt(9)
    ds_read_b64_tr_b16 v[170:171], v213 offset:4608
    buffer_load_dwordx4 v220, s[28:31], s42 offen lds
    v_mfma_f32_16x16x32_bf16 v[28:31], v[156:159], a[0:3], 0
    s_add_u32 m0, s58, 49152
    ds_read_b64_tr_b16 v[172:173], v213 offset:12288
    buffer_load_dwordx4 v216, s[24:27], s40 offen offset:0 lds
    v_mfma_f32_16x16x32_bf16 v[44:47], v[156:159], a[4:7], 0
    buffer_load_dwordx4 v217, s[24:27], s40 offen offset:1024 lds
    buffer_load_dwordx4 v218, s[24:27], s40 offen offset:2048 lds
    buffer_load_dwordx4 v219, s[24:27], s40 offen offset:3072 lds
    s_waitcnt vmcnt(8)
    s_barrier
    v_mfma_f32_16x16x32_bf16 v[60:63], v[156:159], a[8:11], 0
    s_bfe_u32 s49, s48, 0x4000c
    ds_read_b64_tr_b16 v[174:175], v213 offset:12800
    s_mul_i32 s42, s49, 229376
    v_mfma_f32_16x16x32_bf16 v[76:79], v[156:159], a[12:15], 0
    s_waitcnt lgkmcnt(6)
    ds_read_b128 a[32:35], v208 offset:24576
    s_add_u32 s42, s42, s59
    v_mfma_f32_16x16x32_bf16 v[16:19], v[160:163], a[16:19], v[16:19]
    s_lshl_b32 s49, s49, 7
    ds_read_b64_tr_b16 v[144:145], v212 offset:16384
    s_add_u32 s40, s49, s20
    v_mfma_f32_16x16x32_bf16 v[32:35], v[160:163], a[20:23], v[32:35]
    s_add_u32 m0, s44, 49152
    ds_read_b64_tr_b16 v[146:147], v212 offset:16896
    buffer_load_dwordx4 v220, s[28:31], s42 offen lds
    v_mfma_f32_16x16x32_bf16 v[48:51], v[160:163], a[24:27], v[48:51]
    s_add_u32 s42, s42, 57344
    ds_read_b128 a[36:39], v208 offset:26624
    s_add_u32 m0, s44, 51200
    v_mfma_f32_16x16x32_bf16 v[64:67], v[160:163], a[28:31], v[64:67]
    s_waitcnt lgkmcnt(8)
    ds_read_b128 a[40:43], v208 offset:28672
    v_mfma_f32_16x16x32_bf16 v[24:27], v[164:167], a[16:19], v[24:27]
    ds_read_b128 a[44:47], v208 offset:30720
    buffer_load_dwordx4 v220, s[28:31], s42 offen lds
    v_mfma_f32_16x16x32_bf16 v[40:43], v[164:167], a[20:23], v[40:43]
    s_add_u32 s42, s42, 57344
    ds_read_b64_tr_b16 v[148:149], v212 offset:24576
    s_add_u32 m0, s44, 53248
    v_mfma_f32_16x16x32_bf16 v[56:59], v[164:167], a[24:27], v[56:59]
    ds_read_b64_tr_b16 v[150:151], v212 offset:25088
    v_mfma_f32_16x16x32_bf16 v[72:75], v[164:167], a[28:31], v[72:75]
    s_waitcnt lgkmcnt(10)
    ds_read_b64_tr_b16 v[152:153], v213 offset:16384
    buffer_load_dwordx4 v220, s[28:31], s42 offen lds
    v_mfma_f32_16x16x32_bf16 v[20:23], v[168:171], a[16:19], v[20:23]
    s_add_u32 s42, s42, 57344
    ds_read_b64_tr_b16 v[154:155], v213 offset:16896
    s_add_u32 m0, s44, 55296
    v_mfma_f32_16x16x32_bf16 v[36:39], v[168:171], a[20:23], v[36:39]
    ds_read_b64_tr_b16 v[156:157], v213 offset:24576
    buffer_load_dwordx4 v220, s[28:31], s42 offen lds
    v_mfma_f32_16x16x32_bf16 v[52:55], v[168:171], a[24:27], v[52:55]
    s_add_u32 m0, s58, 73728
    ds_read_b64_tr_b16 v[158:159], v213 offset:25088
    v_mfma_f32_16x16x32_bf16 v[68:71], v[168:171], a[28:31], v[68:71]
    s_waitcnt lgkmcnt(12)
    ds_read_b128 a[48:51], v209 offset:24576
    buffer_load_dwordx4 v216, s[24:27], s40 offen offset:0 lds
    v_mfma_f32_16x16x32_bf16 v[28:31], v[172:175], a[16:19], v[28:31]
    ds_read_b64_tr_b16 v[160:161], v212 offset:20480
    v_mfma_f32_16x16x32_bf16 v[44:47], v[172:175], a[20:23], v[44:47]
    ds_read_b64_tr_b16 v[162:163], v212 offset:20992
    buffer_load_dwordx4 v217, s[24:27], s40 offen offset:1024 lds
    v_mfma_f32_16x16x32_bf16 v[60:63], v[172:175], a[24:27], v[60:63]
    ds_read_b128 a[52:55], v209 offset:26624
    v_mfma_f32_16x16x32_bf16 v[76:79], v[172:175], a[28:31], v[76:79]
    s_waitcnt lgkmcnt(10)
    ds_read_b128 a[56:59], v209 offset:28672
    buffer_load_dwordx4 v218, s[24:27], s40 offen offset:2048 lds
    v_mfma_f32_16x16x32_bf16 v[16:19], v[144:147], a[32:35], v[16:19]
    ds_read_b128 a[60:63], v209 offset:30720
    v_mfma_f32_16x16x32_bf16 v[32:35], v[144:147], a[36:39], v[32:35]
    ds_read_b64_tr_b16 v[164:165], v212 offset:28672
    buffer_load_dwordx4 v219, s[24:27], s40 offen offset:3072 lds
    v_mfma_f32_16x16x32_bf16 v[48:51], v[144:147], a[40:43], v[48:51]
    s_bfe_u32 s49, s48, 0x40010
    ds_read_b64_tr_b16 v[166:167], v212 offset:29184
    s_mul_i32 s42, s49, 229376
    v_mfma_f32_16x16x32_bf16 v[64:67], v[144:147], a[44:47], v[64:67]
    s_waitcnt vmcnt(8) lgkmcnt(12)
    s_barrier
    v_mfma_f32_16x16x32_bf16 v[24:27], v[148:151], a[32:35], v[24:27]
    s_add_u32 s42, s42, s59
    ds_read_b64_tr_b16 v[168:169], v213 offset:20480
    s_lshl_b32 s49, s49, 7
    v_mfma_f32_16x16x32_bf16 v[40:43], v[148:151], a[36:39], v[40:43]
    s_add_u32 s40, s49, s20
    ds_read_b64_tr_b16 v[170:171], v213 offset:20992
    s_add_u32 m0, s44, 0
    v_mfma_f32_16x16x32_bf16 v[56:59], v[148:151], a[40:43], v[56:59]
    ds_read_b64_tr_b16 v[172:173], v213 offset:28672
    buffer_load_dwordx4 v220, s[28:31], s42 offen lds
    v_mfma_f32_16x16x32_bf16 v[72:75], v[148:151], a[44:47], v[72:75]
    s_waitcnt lgkmcnt(13)
    ds_read_b64_tr_b16 v[174:175], v213 offset:29184
    s_add_u32 s42, s42, 57344
    v_mfma_f32_16x16x32_bf16 v[20:23], v[152:155], a[32:35], v[20:23]
    s_add_u32 m0, s44, 2048
    ds_read_b128 a[64:67], v210 offset:0
    v_mfma_f32_16x16x32_bf16 v[36:39], v[152:155], a[36:39], v[36:39]
    ds_read_b64_tr_b16 v[144:145], v212 offset:32768
    v_mfma_f32_16x16x32_bf16 v[52:55], v[152:155], a[40:43], v[52:55]
    ds_read_b64_tr_b16 v[146:147], v212 offset:33280
    buffer_load_dwordx4 v220, s[28:31], s42 offen lds
    v_mfma_f32_16x16x32_bf16 v[68:71], v[152:155], a[44:47], v[68:71]
    s_waitcnt lgkmcnt(15)
    ds_read_b128 a[68:71], v210 offset:2048
    s_add_u32 s42, s42, 57344
    v_mfma_f32_16x16x32_bf16 v[28:31], v[156:159], a[32:35], v[28:31]
    s_add_u32 m0, s44, 4096
    ds_read_b128 a[72:75], v210 offset:4096
    v_mfma_f32_16x16x32_bf16 v[44:47], v[156:159], a[36:39], v[44:47]
    ds_read_b128 a[76:79], v210 offset:6144
    v_mfma_f32_16x16x32_bf16 v[60:63], v[156:159], a[40:43], v[60:63]
    ds_read_b64_tr_b16 v[148:149], v212 offset:40960
    buffer_load_dwordx4 v220, s[28:31], s42 offen lds
    v_mfma_f32_16x16x32_bf16 v[76:79], v[156:159], a[44:47], v[76:79]
    s_waitcnt lgkmcnt(13)
    ds_read_b64_tr_b16 v[150:151], v212 offset:41472
    s_add_u32 s42, s42, 57344
    v_mfma_f32_16x16x32_bf16 v[16:19], v[160:163], a[48:51], v[16:19]
    s_add_u32 m0, s44, 6144
    ds_read_b64_tr_b16 v[152:153], v213 offset:32768
    v_mfma_f32_16x16x32_bf16 v[32:35], v[160:163], a[52:55], v[32:35]
    ds_read_b64_tr_b16 v[154:155], v213 offset:33280
    v_mfma_f32_16x16x32_bf16 v[48:51], v[160:163], a[56:59], v[48:51]
    ds_read_b64_tr_b16 v[156:157], v213 offset:40960
    buffer_load_dwordx4 v220, s[28:31], s42 offen lds
    v_mfma_f32_16x16x32_bf16 v[64:67], v[160:163], a[60:63], v[64:67]
    s_waitcnt lgkmcnt(15)
    ds_read_b64_tr_b16 v[158:159], v213 offset:41472
    s_add_u32 m0, s58, 0
    v_mfma_f32_16x16x32_bf16 v[24:27], v[164:167], a[48:51], v[24:27]
    ds_read_b128 a[80:83], v211 offset:0
    v_mfma_f32_16x16x32_bf16 v[40:43], v[164:167], a[52:55], v[40:43]
    ds_read_b64_tr_b16 v[160:161], v212 offset:36864
    v_mfma_f32_16x16x32_bf16 v[56:59], v[164:167], a[56:59], v[56:59]
    ds_read_b64_tr_b16 v[162:163], v212 offset:37376
    buffer_load_dwordx4 v216, s[24:27], s40 offen offset:0 lds
    v_mfma_f32_16x16x32_bf16 v[72:75], v[164:167], a[60:63], v[72:75]
    s_waitcnt lgkmcnt(15)
    ds_read_b128 a[84:87], v211 offset:2048
    v_mfma_f32_16x16x32_bf16 v[20:23], v[168:171], a[48:51], v[20:23]
    ds_read_b128 a[88:91], v211 offset:4096
    v_mfma_f32_16x16x32_bf16 v[36:39], v[168:171], a[52:55], v[36:39]
    ds_read_b128 a[92:95], v211 offset:6144
    v_mfma_f32_16x16x32_bf16 v[52:55], v[168:171], a[56:59], v[52:55]
    ds_read_b64_tr_b16 v[164:165], v212 offset:45056
    buffer_load_dwordx4 v217, s[24:27], s40 offen offset:1024 lds
    v_mfma_f32_16x16x32_bf16 v[68:71], v[168:171], a[60:63], v[68:71]
    ds_read_b64_tr_b16 v[166:167], v212 offset:45568
    v_mfma_f32_16x16x32_bf16 v[28:31], v[172:175], a[48:51], v[28:31]
    ds_read_b64_tr_b16 v[168:169], v213 offset:36864
    v_mfma_f32_16x16x32_bf16 v[44:47], v[172:175], a[52:55], v[44:47]
    ds_read_b64_tr_b16 v[170:171], v213 offset:37376
    buffer_load_dwordx4 v218, s[24:27], s40 offen offset:2048 lds
    v_mfma_f32_16x16x32_bf16 v[60:63], v[172:175], a[56:59], v[60:63]
    v_mfma_f32_16x16x32_bf16 v[76:79], v[172:175], a[60:63], v[76:79]
    s_waitcnt lgkmcnt(15)
    v_mfma_f32_16x16x32_bf16 v[16:19], v[144:147], a[64:67], v[16:19]
    ds_read_b64_tr_b16 v[172:173], v213 offset:45056
    buffer_load_dwordx4 v219, s[24:27], s40 offen offset:3072 lds
    v_mfma_f32_16x16x32_bf16 v[32:35], v[144:147], a[68:71], v[32:35]
    s_bfe_u32 s49, s48, 0x40014
    ds_read_b64_tr_b16 v[174:175], v213 offset:45568
    s_mul_i32 s42, s49, 229376
    v_mfma_f32_16x16x32_bf16 v[48:51], v[144:147], a[72:75], v[48:51]
    s_add_u32 s42, s42, s59
    s_lshl_b32 s49, s49, 7
    s_add_u32 s40, s49, s20
    v_mfma_f32_16x16x32_bf16 v[64:67], v[144:147], a[76:79], v[64:67]
    s_waitcnt vmcnt(8) lgkmcnt(15)
    s_barrier
    v_mfma_f32_16x16x32_bf16 v[24:27], v[148:151], a[64:67], v[24:27]
    s_add_u32 m0, s44, 16384
    ds_read_b128 a[96:99], v210 offset:24576
    buffer_load_dwordx4 v220, s[28:31], s42 offen lds
    v_mfma_f32_16x16x32_bf16 v[40:43], v[148:151], a[68:71], v[40:43]
    s_branch SEG0
.p2align 12
PAD0:
    s_branch PADRET0
    s_nop 0
SEG0:
    s_add_u32 s42, s42, 57344
    ds_read_b64_tr_b16 v[144:145], v212 offset:49152
    s_add_u32 m0, s44, 18432
    v_mfma_f32_16x16x32_bf16 v[56:59], v[148:151], a[72:75], v[56:59]
    ds_read_b64_tr_b16 v[146:147], v212 offset:49664
    v_mfma_f32_16x16x32_bf16 v[72:75], v[148:151], a[76:79], v[72:75]
    s_waitcnt lgkmcnt(15)
    ds_read_b128 a[100:103], v210 offset:26624
    v_mfma_f32_16x16x32_bf16 v[20:23], v[152:155], a[64:67], v[20:23]
    ds_read_b128 a[104:107], v210 offset:28672
    buffer_load_dwordx4 v220, s[28:31], s42 offen lds
    v_mfma_f32_16x16x32_bf16 v[36:39], v[152:155], a[68:71], v[36:39]
    s_add_u32 s42, s42, 57344
    ds_read_b128 a[108:111], v210 offset:30720
    s_add_u32 m0, s44, 20480
    v_mfma_f32_16x16x32_bf16 v[52:55], v[152:155], a[72:75], v[52:55]
    ds_read_b64_tr_b16 v[148:149], v212 offset:57344
    v_mfma_f32_16x16x32_bf16 v[68:71], v[152:155], a[76:79], v[68:71]
    ds_read_b64_tr_b16 v[150:151], v212 offset:57856
    v_mfma_f32_16x16x32_bf16 v[28:31], v[156:159], a[64:67], v[28:31]
    ds_read_b64_tr_b16 v[152:153], v213 offset:49152
    buffer_load_dwordx4 v220, s[28:31], s42 offen lds
    v_mfma_f32_16x16x32_bf16 v[44:47], v[156:159], a[68:71], v[44:47]
    s_add_u32 s42, s42, 57344
    ds_read_b64_tr_b16 v[154:155], v213 offset:49664
    s_add_u32 m0, s44, 22528
    v_mfma_f32_16x16x32_bf16 v[60:63], v[156:159], a[72:75], v[60:63]
    ds_read_b128 a[112:115], v211 offset:24576
    v_mfma_f32_16x16x32_bf16 v[76:79], v[156:159], a[76:79], v[76:79]
    s_waitcnt lgkmcnt(15)
    ds_read_b128 a[116:119], v211 offset:26624
    v_mfma_f32_16x16x32_bf16 v[16:19], v[160:163], a[80:83], v[16:19]
    ds_read_b64_tr_b16 v[156:157], v213 offset:57344
    buffer_load_dwordx4 v220, s[28:31], s42 offen lds
    v_mfma_f32_16x16x32_bf16 v[32:35], v[160:163], a[84:87], v[32:35]
    s_add_u32 m0, s58, 24576
    ds_read_b64_tr_b16 v[158:159], v213 offset:57856
    v_mfma_f32_16x16x32_bf16 v[48:51], v[160:163], a[88:91], v[48:51]
    ds_read_b128 a[120:123], v211 offset:28672
    v_mfma_f32_16x16x32_bf16 v[64:67], v[160:163], a[92:95], v[64:67]
    ds_read_b128 a[124:127], v211 offset:30720
    v_mfma_f32_16x16x32_bf16 v[24:27], v[164:167], a[80:83], v[24:27]
    ds_read_b64_tr_b16 v[160:161], v212 offset:53248
    buffer_load_dwordx4 v216, s[24:27], s40 offen offset:0 lds
    v_mfma_f32_16x16x32_bf16 v[40:43], v[164:167], a[84:87], v[40:43]
    ds_read_b64_tr_b16 v[162:163], v212 offset:53760
    v_mfma_f32_16x16x32_bf16 v[56:59], v[164:167], a[88:91], v[56:59]
    v_mfma_f32_16x16x32_bf16 v[72:75], v[164:167], a[92:95], v[72:75]
    s_waitcnt lgkmcnt(15)
    v_mfma_f32_16x16x32_bf16 v[20:23], v[168:171], a[80:83], v[20:23]
    ds_read_b64_tr_b16 v[164:165], v212 offset:61440
    buffer_load_dwordx4 v217, s[24:27], s40 offen offset:1024 lds
    v_mfma_f32_16x16x32_bf16 v[36:39], v[168:171], a[84:87], v[36:39]
    ds_read_b64_tr_b16 v[166:167], v212 offset:61952
    v_mfma_f32_16x16x32_bf16 v[52:55], v[168:171], a[88:91], v[52:55]
    v_mfma_f32_16x16x32_bf16 v[68:71], v[168:171], a[92:95], v[68:71]
    v_mfma_f32_16x16x32_bf16 v[28:31], v[172:175], a[80:83], v[28:31]
    ds_read_b64_tr_b16 v[168:169], v213 offset:53248
    buffer_load_dwordx4 v218, s[24:27], s40 offen offset:2048 lds
    v_mfma_f32_16x16x32_bf16 v[44:47], v[172:175], a[84:87], v[44:47]
    ds_read_b64_tr_b16 v[170:171], v213 offset:53760
    v_mfma_f32_16x16x32_bf16 v[60:63], v[172:175], a[88:91], v[60:63]
    v_mfma_f32_16x16x32_bf16 v[76:79], v[172:175], a[92:95], v[76:79]
    s_add_u32 s1, s0, 0x10000
    s_add_u32 s100, s0, 4096
    s_add_u32 s101, s1, 4096
    s_mov_b32 s32, s16
    s_and_b32 s33, s17, 0xffff
    s_mov_b32 s34, 15204352
    s_mov_b32 s35, 0x20000
    s_mov_b32 s36, s10
    s_and_b32 s37, s11, 0xffff
    s_mov_b32 s38, 1835008
    s_mov_b32 s39, 0x20000
    v_lshlrev_b32 v221, 4, v2
    v_mov_b32 v6, 0x88884000
    v_lshlrev_b32 v7, 2, v3
    v_bfe_u32 v6, v6, v7, 4
    v_lshl_add_u32 v221, v6, 7, v221
    v_mov_b32 v240, 0
    v_lshlrev_b32 v6, 1, v5
    v_xor_b32 v6, v6, v4
    v_lshlrev_b32 v6, 4, v6
    v_lshl_add_u32 v6, v3, 10, v6
    s_lshl_b32 s23, s22, 7
    v_add_u32 v226, s23, v6
    v_add_u32 v227, 7168, v226
    v_add_u32 v228, 16384, v226
    v_add_u32 v229, 16384, v227
    v_lshrrev_b32 v6, 2, v2
    v_lshlrev_b32 v6, 7, v6
    v_and_b32 v7, 3, v3
    v_lshl_add_u32 v6, v7, 5, v6
    v_and_b32 v7, 3, v2
    v_lshl_add_u32 v6, v7, 3, v6
    v_add_u32 v244, s43, v6
    v_xor_b32 v245, 32, v244
    v_xor_b32 v246, 64, v244
    v_xor_b32 v247, 96, v244
    s_lshl_b32 s23, s21, 2
    s_add_u32 s23, s23, s18
    s_lshl_b32 s23, s23, 12
    s_add_u32 s23, s23, 14680064
    s_add_u32 s52, s16, s23
    s_addc_u32 s53, s17, 0
    s_mul_i32 s23, s18, 7
    s_and_b32 s57, s23, 1
    s_lshl_b32 s23, s23, 1
    s_sub_u32 s23, s23, s57
    s_lshl_b32 s4, s23, 15
    s_lshl_b32 s57, s57, 16
    s_add_u32 s57, s57, 0x8000
    s_add_u32 s5, s4, s57
    s_add_u32 s6, s4, 0x20000
    s_add_u32 s7, s5, 0x20000
    s_add_u32 s8, s6, 0x20000
    s_add_u32 s9, s7, 0x20000
    s_add_u32 s10, s8, 0x20000
    s_add_u32 s57, s22, s21
    s_mov_b32 s23, s4
    s_bitcmp1_b32 s57, 0
    s_cselect_b32 s4, s8, s4
    s_cselect_b32 s8, s5, s8
    s_cselect_b32 s5, s9, s5
    s_cselect_b32 s9, s6, s9
    s_cselect_b32 s6, s10, s6
    s_cselect_b32 s10, s7, s10
    s_cselect_b32 s7, s23, s7
    s_lshr_b32 s23, s21, 2
    s_mul_i32 s23, s23, 1835008
    s_and_b32 s57, s21, 3
    s_lshl_b32 s57, s57, 13
    s_add_u32 s23, s23, s57
    v_add_u32 v242, s23, v221
    v_add_u32 v243, 4096, v242
    v_lshrrev_b32 v6, 1, v4
    v_mul_u32_u24 v6, 1280, v6
    v_bfe_u32 v7, v4, 1, 1
    v_lshl_add_u32 v6, v7, 4, v6
    v_and_b32 v7, 1, v4
    v_lshl_add_u32 v6, v7, 5, v6
    v_lshrrev_b32 v7, 5, v2
    v_lshl_add_u32 v6, v7, 6, v6
    v_and_b32 v7, 3, v3
    v_mul_u32_u24 v7, 320, v7
    v_add_u32 v6, v6, v7
    s_lshr_b32 s23, s18, 1
    s_mul_i32 s23, s23, 5120
    s_and_b32 s57, s18, 1
    s_lshl_b32 s57, s57, 7
    s_add_u32 s23, s23, s57
    v_add_u32 v231, s23, v6
    v_add_u32 v232, 49152, v231
    v_lshlrev_b32 v6, 4, v4
    v_lshl_add_u32 v234, v3, 10, v6
    s_lshl_b32 s3, s21, 16
    s_lshl_b32 s23, s18, 13
    s_add_u32 s3, s3, s23
    s_lshl_b32 s23, s22, 7
    s_add_u32 s3, s3, s23
    s_mov_b32 s11, 0
    s_cmp_eq_u32 s18, 1
    s_cbranch_scc1 PAD1
PADRET1:
    s_cmp_eq_u32 s18, 2
    s_cbranch_scc1 PAD2
PADRET2:
    s_cmp_eq_u32 s18, 3
    s_cbranch_scc1 PAD3
PADRET3:
    v_mfma_f32_16x16x32_bf16 v[16:19], v[144:147], a[96:99], v[16:19]
    s_waitcnt lgkmcnt(14)
    ds_read_b64_tr_b16 v[172:173], v213 offset:61440
    buffer_load_dwordx4 v219, s[24:27], s40 offen offset:3072 lds
    v_mfma_f32_16x16x32_bf16 v[32:35], v[144:147], a[100:103], v[32:35]
    s_bfe_u32 s49, s48, 0x40018
    ds_read_b64_tr_b16 v[174:175], v213 offset:61952
    s_mul_i32 s42, s49, 229376
    v_mfma_f32_16x16x32_bf16 v[48:51], v[144:147], a[104:107], v[48:51]
    s_add_u32 s42, s42, s59
    s_lshl_b32 s49, s49, 7
    s_add_u32 s40, s49, s20
    v_mfma_f32_16x16x32_bf16 v[64:67], v[144:147], a[108:111], v[64:67]
    s_waitcnt vmcnt(8)
    s_barrier
    v_mfma_f32_16x16x32_bf16 v[24:27], v[148:151], a[96:99], v[24:27]
    s_add_u32 m0, s44, 32768
    ds_read_b128 a[128:131], v208 offset:0
    buffer_load_dwordx4 v220, s[28:31], s42 offen lds
    v_mfma_f32_16x16x32_bf16 v[40:43], v[148:151], a[100:103], v[40:43]
    s_add_u32 s42, s42, 57344
    ds_read_b64_tr_b16 v[144:145], v212 offset:0
    s_add_u32 m0, s44, 34816
    v_mfma_f32_16x16x32_bf16 v[56:59], v[148:151], a[104:107], v[56:59]
    ds_read_b64_tr_b16 v[146:147], v212 offset:512
    v_mfma_f32_16x16x32_bf16 v[72:75], v[148:151], a[108:111], v[72:75]
    s_waitcnt lgkmcnt(15)
    ds_read_b128 a[132:135], v208 offset:2048
    v_mfma_f32_16x16x32_bf16 v[20:23], v[152:155], a[96:99], v[20:23]
    ds_read_b128 a[136:139], v208 offset:4096
    buffer_load_dwordx4 v220, s[28:31], s42 offen lds
    v_mfma_f32_16x16x32_bf16 v[36:39], v[152:155], a[100:103], v[36:39]
    s_add_u32 s42, s42, 57344
    ds_read_b128 a[140:143], v208 offset:6144
    s_add_u32 m0, s44, 36864
    v_mfma_f32_16x16x32_bf16 v[52:55], v[152:155], a[104:107], v[52:55]
    ds_read_b64_tr_b16 v[148:149], v212 offset:8192
    v_mfma_f32_16x16x32_bf16 v[68:71], v[152:155], a[108:111], v[68:71]
    s_waitcnt lgkmcnt(15)
    ds_read_b64_tr_b16 v[150:151], v212 offset:8704
    v_mfma_f32_16x16x32_bf16 v[28:31], v[156:159], a[96:99], v[28:31]
    ds_read_b64_tr_b16 v[152:153], v213 offset:0
    buffer_load_dwordx4 v220, s[28:31], s42 offen lds
    v_mfma_f32_16x16x32_bf16 v[44:47], v[156:159], a[100:103], v[44:47]
    s_add_u32 s42, s42, 57344
    ds_read_b64_tr_b16 v[154:155], v213 offset:512
    s_add_u32 m0, s44, 38912
    v_mfma_f32_16x16x32_bf16 v[60:63], v[156:159], a[104:107], v[60:63]
    ds_read_b128 a[144:147], v209 offset:0
    v_mfma_f32_16x16x32_bf16 v[76:79], v[156:159], a[108:111], v[76:79]
    s_waitcnt lgkmcnt(15)
    ds_read_b128 a[148:151], v209 offset:2048
    v_mfma_f32_16x16x32_bf16 v[16:19], v[160:163], a[112:115], v[16:19]
    ds_read_b64_tr_b16 v[156:157], v213 offset:8192
    buffer_load_dwordx4 v220, s[28:31], s42 offen lds
    v_mfma_f32_16x16x32_bf16 v[32:35], v[160:163], a[116:119], v[32:35]
    s_add_u32 m0, s58, 49152
    ds_read_b64_tr_b16 v[158:159], v213 offset:8704
    v_mfma_f32_16x16x32_bf16 v[48:51], v[160:163], a[120:123], v[48:51]
    ds_read_b128 a[152:155], v209 offset:4096
    v_mfma_f32_16x16x32_bf16 v[64:67], v[160:163], a[124:127], v[64:67]
    ds_read_b128 a[156:159], v209 offset:6144
    v_mfma_f32_16x16x32_bf16 v[24:27], v[164:167], a[112:115], v[24:27]
    ds_read_b64_tr_b16 v[160:161], v212 offset:4096
    buffer_load_dwordx4 v216, s[24:27], s40 offen offset:0 lds
    v_mfma_f32_16x16x32_bf16 v[40:43], v[164:167], a[116:119], v[40:43]
    ds_read_b64_tr_b16 v[162:163], v212 offset:4608
    v_mfma_f32_16x16x32_bf16 v[56:59], v[164:167], a[120:123], v[56:59]
    v_mfma_f32_16x16x32_bf16 v[72:75], v[164:167], a[124:127], v[72:75]
    s_waitcnt lgkmcnt(15)
    v_mfma_f32_16x16x32_bf16 v[20:23], v[168:171], a[112:115], v[20:23]
    ds_read_b64_tr_b16 v[164:165], v212 offset:12288
    buffer_load_dwordx4 v217, s[24:27], s40 offen offset:1024 lds
    v_mfma_f32_16x16x32_bf16 v[36:39], v[168:171], a[116:119], v[36:39]
    ds_read_b64_tr_b16 v[166:167], v212 offset:12800
    v_mfma_f32_16x16x32_bf16 v[52:55], v[168:171], a[120:123], v[52:55]
    v_mfma_f32_16x16x32_bf16 v[68:71], v[168:171], a[124:127], v[68:71]
    v_mfma_f32_16x16x32_bf16 v[28:31], v[172:175], a[112:115], v[28:31]
    ds_read_b64_tr_b16 v[168:169], v213 offset:4096
    buffer_load_dwordx4 v218, s[24:27], s40 offen offset:2048 lds
    v_mfma_f32_16x16x32_bf16 v[44:47], v[172:175], a[116:119], v[44:47]
    ds_read_b64_tr_b16 v[170:171], v213 offset:4608
    v_mfma_f32_16x16x32_bf16 v[60:63], v[172:175], a[120:123], v[60:63]
    v_mfma_f32_16x16x32_bf16 v[76:79], v[172:175], a[124:127], v[76:79]
    v_mfma_f32_16x16x32_bf16 v[16:19], v[144:147], a[128:131], v[16:19]
    s_waitcnt lgkmcnt(14)
    ds_read_b64_tr_b16 v[172:173], v213 offset:12288
    buffer_load_dwordx4 v219, s[24:27], s40 offen offset:3072 lds
    v_mfma_f32_16x16x32_bf16 v[32:35], v[144:147], a[132:135], v[32:35]
    s_bfe_u32 s49, s48, 0x4001c
    ds_read_b64_tr_b16 v[174:175], v213 offset:12800
    s_mul_i32 s42, s49, 229376
    v_mfma_f32_16x16x32_bf16 v[48:51], v[144:147], a[136:139], v[48:51]
    s_add_u32 s42, s42, s59
    s_lshl_b32 s49, s49, 7
    s_add_u32 s40, s49, s20
    v_mfma_f32_16x16x32_bf16 v[64:67], v[144:147], a[140:143], v[64:67]
    s_waitcnt vmcnt(8)
    s_barrier
    v_mfma_f32_16x16x32_bf16 v[24:27], v[148:151], a[128:131], v[24:27]
    s_add_u32 s59, s59, 128
    ds_read_b128 a[160:163], v208 offset:24576
    s_add_u32 m0, s44, 49152
    v_mfma_f32_16x16x32_bf16 v[40:43], v[148:151], a[132:135], v[40:43]
    ds_read_b64_tr_b16 v[144:145], v212 offset:16384
    buffer_load_dwordx4 v220, s[28:31], s42 offen lds
    v_mfma_f32_16x16x32_bf16 v[56:59], v[148:151], a[136:139], v[56:59]
    s_add_u32 s42, s42, 57344
    ds_read_b64_tr_b16 v[146:147], v212 offset:16896
    s_add_u32 m0, s44, 51200
    v_mfma_f32_16x16x32_bf16 v[72:75], v[148:151], a[140:143], v[72:75]
    s_waitcnt lgkmcnt(15)
    ds_read_b128 a[164:167], v208 offset:26624
    v_mfma_f32_16x16x32_bf16 v[20:23], v[152:155], a[128:131], v[20:23]
    ds_read_b128 a[168:171], v208 offset:28672
    v_mfma_f32_16x16x32_bf16 v[36:39], v[152:155], a[132:135], v[36:39]
    ds_read_b128 a[172:175], v208 offset:30720
    buffer_load_dwordx4 v220, s[28:31], s42 offen lds
    v_mfma_f32_16x16x32_bf16 v[52:55], v[152:155], a[136:139], v[52:55]
    s_add_u32 s42, s42, 57344
    ds_read_b64_tr_b16 v[148:149], v212 offset:24576
    s_add_u32 m0, s44, 53248
    v_mfma_f32_16x16x32_bf16 v[68:71], v[152:155], a[140:143], v[68:71]
    s_waitcnt lgkmcnt(15)
    ds_read_b64_tr_b16 v[150:151], v212 offset:25088
    v_mfma_f32_16x16x32_bf16 v[28:31], v[156:159], a[128:131], v[28:31]
    ds_read_b64_tr_b16 v[152:153], v213 offset:16384
    v_mfma_f32_16x16x32_bf16 v[44:47], v[156:159], a[132:135], v[44:47]
    ds_read_b64_tr_b16 v[154:155], v213 offset:16896
    buffer_load_dwordx4 v220, s[28:31], s42 offen lds
    v_mfma_f32_16x16x32_bf16 v[60:63], v[156:159], a[136:139], v[60:63]
    s_add_u32 s42, s42, 57344
    ds_read_b128 a[176:179], v209 offset:24576
    s_add_u32 m0, s44, 55296
    v_mfma_f32_16x16x32_bf16 v[76:79], v[156:159], a[140:143], v[76:79]
    s_waitcnt lgkmcnt(15)
    ds_read_b128 a[180:183], v209 offset:26624
    v_mfma_f32_16x16x32_bf16 v[16:19], v[160:163], a[144:147], v[16:19]
    ds_read_b64_tr_b16 v[156:157], v213 offset:24576
    v_mfma_f32_16x16x32_bf16 v[32:35], v[160:163], a[148:151], v[32:35]
    ds_read_b64_tr_b16 v[158:159], v213 offset:25088
    buffer_load_dwordx4 v220, s[28:31], s42 offen lds
    v_mfma_f32_16x16x32_bf16 v[48:51], v[160:163], a[152:155], v[48:51]
    s_add_u32 m0, s58, 73728
    ds_read_b128 a[184:187], v209 offset:28672
    v_mfma_f32_16x16x32_bf16 v[64:67], v[160:163], a[156:159], v[64:67]
    ds_read_b128 a[188:191], v209 offset:30720
    v_mfma_f32_16x16x32_bf16 v[24:27], v[164:167], a[144:147], v[24:27]
    ds_read_b64_tr_b16 v[160:161], v212 offset:20480
    v_mfma_f32_16x16x32_bf16 v[40:43], v[164:167], a[148:151], v[40:43]
    ds_read_b64_tr_b16 v[162:163], v212 offset:20992
    buffer_load_dwordx4 v216, s[24:27], s40 offen offset:0 lds
    v_mfma_f32_16x16x32_bf16 v[56:59], v[164:167], a[152:155], v[56:59]
    v_mfma_f32_16x16x32_bf16 v[72:75], v[164:167], a[156:159], v[72:75]
    s_waitcnt lgkmcnt(15)
    v_mfma_f32_16x16x32_bf16 v[20:23], v[168:171], a[144:147], v[20:23]
    ds_read_b64_tr_b16 v[164:165], v212 offset:28672
    v_mfma_f32_16x16x32_bf16 v[36:39], v[168:171], a[148:151], v[36:39]
    ds_read_b64_tr_b16 v[166:167], v212 offset:29184
    buffer_load_dwordx4 v217, s[24:27], s40 offen offset:1024 lds
    v_mfma_f32_16x16x32_bf16 v[52:55], v[168:171], a[152:155], v[52:55]
    v_mfma_f32_16x16x32_bf16 v[68:71], v[168:171], a[156:159], v[68:71]
    v_mfma_f32_16x16x32_bf16 v[28:31], v[172:175], a[144:147], v[28:31]
    ds_read_b64_tr_b16 v[168:169], v213 offset:20480
    v_mfma_f32_16x16x32_bf16 v[44:47], v[172:175], a[148:151], v[44:47]
    ds_read_b64_tr_b16 v[170:171], v213 offset:20992
    buffer_load_dwordx4 v218, s[24:27], s40 offen offset:2048 lds
    v_mfma_f32_16x16x32_bf16 v[60:63], v[172:175], a[152:155], v[60:63]
    v_mfma_f32_16x16x32_bf16 v[76:79], v[172:175], a[156:159], v[76:79]
    v_mfma_f32_16x16x32_bf16 v[16:19], v[144:147], a[160:163], v[16:19]
    s_waitcnt lgkmcnt(14)
    ds_read_b64_tr_b16 v[172:173], v213 offset:28672
    buffer_load_dwordx4 v219, s[24:27], s40 offen offset:3072 lds
    v_mfma_f32_16x16x32_bf16 v[32:35], v[144:147], a[164:167], v[32:35]
    s_bfe_u32 s49, s48, 0x40000
    ds_read_b64_tr_b16 v[174:175], v213 offset:29184
    s_mul_i32 s42, s49, 229376
    v_mfma_f32_16x16x32_bf16 v[48:51], v[144:147], a[168:171], v[48:51]
    s_add_u32 s42, s42, s59
    v_mfma_f32_16x16x32_bf16 v[64:67], v[144:147], a[172:175], v[64:67]
    s_waitcnt vmcnt(8)
    s_barrier
    v_mfma_f32_16x16x32_bf16 v[24:27], v[148:151], a[160:163], v[24:27]
    s_add_u32 m0, s44, 0
    ds_read_b128 a[192:195], v210 offset:0
    v_mfma_f32_16x16x32_bf16 v[40:43], v[148:151], a[164:167], v[40:43]
    ds_read_b64_tr_b16 v[144:145], v212 offset:32768
    buffer_load_dwordx4 v220, s[28:31], s42 offen lds
    v_mfma_f32_16x16x32_bf16 v[56:59], v[148:151], a[168:171], v[56:59]
    s_add_u32 s42, s42, 57344
    ds_read_b64_tr_b16 v[146:147], v212 offset:33280
    s_add_u32 m0, s44, 2048
    v_mfma_f32_16x16x32_bf16 v[72:75], v[148:151], a[172:175], v[72:75]
    s_waitcnt lgkmcnt(15)
    ds_read_b128 a[196:199], v210 offset:2048
    v_mfma_f32_16x16x32_bf16 v[20:23], v[152:155], a[160:163], v[20:23]
    ds_read_b128 a[200:203], v210 offset:4096
    v_mfma_f32_16x16x32_bf16 v[36:39], v[152:155], a[164:167], v[36:39]
    ds_read_b128 a[204:207], v210 offset:6144
    buffer_load_dwordx4 v220, s[28:31], s42 offen lds
    v_mfma_f32_16x16x32_bf16 v[52:55], v[152:155], a[168:171], v[52:55]
    s_add_u32 s42, s42, 57344
    ds_read_b64_tr_b16 v[148:149], v212 offset:40960
    s_add_u32 m0, s44, 4096
    v_mfma_f32_16x16x32_bf16 v[68:71], v[152:155], a[172:175], v[68:71]
    s_waitcnt lgkmcnt(15)
    ds_read_b64_tr_b16 v[150:151], v212 offset:41472
    v_mfma_f32_16x16x32_bf16 v[28:31], v[156:159], a[160:163], v[28:31]
    ds_read_b64_tr_b16 v[152:153], v213 offset:32768
    v_mfma_f32_16x16x32_bf16 v[44:47], v[156:159], a[164:167], v[44:47]
    ds_read_b64_tr_b16 v[154:155], v213 offset:33280
    v_mfma_f32_16x16x32_bf16 v[60:63], v[156:159], a[168:171], v[60:63]
    ds_read_b128 a[208:211], v211 offset:0
    buffer_load_dwordx4 v220, s[28:31], s42 offen lds
    v_mfma_f32_16x16x32_bf16 v[76:79], v[156:159], a[172:175], v[76:79]
    s_waitcnt lgkmcnt(15)
    ds_read_b128 a[212:215], v211 offset:2048
    s_add_u32 s42, s42, 57344
    v_mfma_f32_16x16x32_bf16 v[16:19], v[160:163], a[176:179], v[16:19]
    s_add_u32 m0, s44, 6144
    ds_read_b64_tr_b16 v[156:157], v213 offset:40960
    v_mfma_f32_16x16x32_bf16 v[32:35], v[160:163], a[180:183], v[32:35]
    ds_read_b64_tr_b16 v[158:159], v213 offset:41472
    v_mfma_f32_16x16x32_bf16 v[48:51], v[160:163], a[184:187], v[48:51]
    ds_read_b128 a[216:219], v211 offset:4096
    buffer_load_dwordx4 v220, s[28:31], s42 offen lds
    v_mfma_f32_16x16x32_bf16 v[64:67], v[160:163], a[188:191], v[64:67]
    s_bfe_u32 s49, s48, 0x40004
    ds_read_b128 a[220:223], v211 offset:6144
    s_mul_i32 s42, s49, 229376
    v_mfma_f32_16x16x32_bf16 v[24:27], v[164:167], a[176:179], v[24:27]
    s_add_u32 s42, s42, s59
    ds_read_b64_tr_b16 v[160:161], v212 offset:36864
    s_add_u32 m0, s43, 16384
    v_mfma_f32_16x16x32_bf16 v[40:43], v[164:167], a[180:183], v[40:43]
    ds_read_b64_tr_b16 v[162:163], v212 offset:37376
    v_mfma_f32_16x16x32_bf16 v[56:59], v[164:167], a[184:187], v[56:59]
    v_mfma_f32_16x16x32_bf16 v[72:75], v[164:167], a[188:191], v[72:75]
    s_waitcnt lgkmcnt(15)
    buffer_load_dwordx4 v226, s[36:39], s4 offen offset:0 lds
    v_mfma_f32_16x16x32_bf16 v[20:23], v[168:171], a[176:179], v[20:23]
    ds_read_b64_tr_b16 v[164:165], v212 offset:45056
    v_mfma_f32_16x16x32_bf16 v[36:39], v[168:171], a[180:183], v[36:39]
    ds_read_b64_tr_b16 v[166:167], v212 offset:45568
    v_mfma_f32_16x16x32_bf16 v[52:55], v[168:171], a[184:187], v[52:55]
    v_mfma_f32_16x16x32_bf16 v[68:71], v[168:171], a[188:191], v[68:71]
    buffer_load_dwordx4 v227, s[36:39], s4 offen offset:1024 lds
    s_add_u32 m0, s43, 18432
    v_mfma_f32_16x16x32_bf16 v[28:31], v[172:175], a[176:179], v[28:31]
    ds_read_b64_tr_b16 v[168:169], v213 offset:36864
    v_mfma_f32_16x16x32_bf16 v[44:47], v[172:175], a[180:183], v[44:47]
    ds_read_b64_tr_b16 v[170:171], v213 offset:37376
    v_mfma_f32_16x16x32_bf16 v[60:63], v[172:175], a[184:187], v[60:63]
    v_mfma_f32_16x16x32_bf16 v[76:79], v[172:175], a[188:191], v[76:79]
    v_mfma_f32_16x16x32_bf16 v[16:19], v[144:147], a[192:195], v[16:19]
    s_waitcnt lgkmcnt(14)
    ds_read_b64_tr_b16 v[172:173], v213 offset:45056
    buffer_load_dwordx4 v228, s[36:39], s4 offen offset:0 lds
    v_mfma_f32_16x16x32_bf16 v[32:35], v[144:147], a[196:199], v[32:35]
    ds_read_b64_tr_b16 v[174:175], v213 offset:45568
    v_mfma_f32_16x16x32_bf16 v[48:51], v[144:147], a[200:203], v[48:51]
    v_mfma_f32_16x16x32_bf16 v[64:67], v[144:147], a[204:207], v[64:67]
    s_waitcnt vmcnt(7)
    s_barrier
    v_mfma_f32_16x16x32_bf16 v[24:27], v[148:151], a[192:195], v[24:27]
    ds_read_b128 a[224:227], v210 offset:24576
    buffer_load_dwordx4 v229, s[36:39], s4 offen offset:1024 lds
    v_mfma_f32_16x16x32_bf16 v[40:43], v[148:151], a[196:199], v[40:43]
    s_add_u32 m0, s43, 20480
    ds_read_b64_tr_b16 v[144:145], v212 offset:49152
    v_mfma_f32_16x16x32_bf16 v[56:59], v[148:151], a[200:203], v[56:59]
    ds_read_b64_tr_b16 v[146:147], v212 offset:49664
    v_mfma_f32_16x16x32_bf16 v[72:75], v[148:151], a[204:207], v[72:75]
    s_waitcnt lgkmcnt(15)
    ds_read_b128 a[228:231], v210 offset:26624
    v_mfma_f32_16x16x32_bf16 v[20:23], v[152:155], a[192:195], v[20:23]
    ds_read_b128 a[232:235], v210 offset:28672
    v_mfma_f32_16x16x32_bf16 v[36:39], v[152:155], a[196:199], v[36:39]
    ds_read_b128 a[236:239], v210 offset:30720
    buffer_load_dwordx4 v226, s[36:39], s5 offen offset:0 lds
    v_mfma_f32_16x16x32_bf16 v[52:55], v[152:155], a[200:203], v[52:55]
    ds_read_b64_tr_b16 v[148:149], v212 offset:57344
    v_mfma_f32_16x16x32_bf16 v[68:71], v[152:155], a[204:207], v[68:71]
    s_waitcnt lgkmcnt(15)
    ds_read_b64_tr_b16 v[150:151], v212 offset:57856
    v_mfma_f32_16x16x32_bf16 v[28:31], v[156:159], a[192:195], v[28:31]
    ds_read_b64_tr_b16 v[152:153], v213 offset:49152
    v_mfma_f32_16x16x32_bf16 v[44:47], v[156:159], a[196:199], v[44:47]
    ds_read_b64_tr_b16 v[154:155], v213 offset:49664
    buffer_load_dwordx4 v227, s[36:39], s5 offen offset:1024 lds
    v_mfma_f32_16x16x32_bf16 v[60:63], v[156:159], a[200:203], v[60:63]
    s_add_u32 m0, s44, 16384
    ds_read_b128 a[240:243], v211 offset:24576
    v_mfma_f32_16x16x32_bf16 v[76:79], v[156:159], a[204:207], v[76:79]
    s_waitcnt lgkmcnt(15)
    ds_read_b128 a[244:247], v211 offset:26624
    v_mfma_f32_16x16x32_bf16 v[16:19], v[160:163], a[208:211], v[16:19]
    ds_read_b64_tr_b16 v[156:157], v213 offset:57344
    v_mfma_f32_16x16x32_bf16 v[32:35], v[160:163], a[212:215], v[32:35]
    ds_read_b64_tr_b16 v[158:159], v213 offset:57856
    v_mfma_f32_16x16x32_bf16 v[48:51], v[160:163], a[216:219], v[48:51]
    ds_read_b128 a[248:251], v211 offset:28672
    buffer_load_dwordx4 v220, s[28:31], s42 offen lds
    v_mfma_f32_16x16x32_bf16 v[64:67], v[160:163], a[220:223], v[64:67]
    s_add_u32 s42, s42, 57344
    ds_read_b128 a[252:255], v211 offset:30720
    s_add_u32 m0, s44, 18432
    v_mfma_f32_16x16x32_bf16 v[24:27], v[164:167], a[208:211], v[24:27]
    ds_read_b64_tr_b16 v[160:161], v212 offset:53248
    v_mfma_f32_16x16x32_bf16 v[40:43], v[164:167], a[212:215], v[40:43]
    ds_read_b64_tr_b16 v[162:163], v212 offset:53760
    v_mfma_f32_16x16x32_bf16 v[56:59], v[164:167], a[216:219], v[56:59]
    buffer_load_dwordx4 v220, s[28:31], s42 offen lds
    s_add_u32 s42, s42, 57344
    v_mfma_f32_16x16x32_bf16 v[72:75], v[164:167], a[220:223], v[72:75]
    s_waitcnt lgkmcnt(15)
    s_add_u32 m0, s44, 20480
    v_mfma_f32_16x16x32_bf16 v[20:23], v[168:171], a[208:211], v[20:23]
    ds_read_b64_tr_b16 v[164:165], v212 offset:61440
    v_mfma_f32_16x16x32_bf16 v[36:39], v[168:171], a[212:215], v[36:39]
    ds_read_b64_tr_b16 v[166:167], v212 offset:61952
    v_mfma_f32_16x16x32_bf16 v[52:55], v[168:171], a[216:219], v[52:55]
    v_mfma_f32_16x16x32_bf16 v[68:71], v[168:171], a[220:223], v[68:71]
    buffer_load_dwordx4 v220, s[28:31], s42 offen lds
    s_add_u32 s42, s42, 57344
    v_mfma_f32_16x16x32_bf16 v[28:31], v[172:175], a[208:211], v[28:31]
    s_add_u32 m0, s44, 22528
    ds_read_b64_tr_b16 v[168:169], v213 offset:53248
    v_mfma_f32_16x16x32_bf16 v[44:47], v[172:175], a[212:215], v[44:47]
    ds_read_b64_tr_b16 v[170:171], v213 offset:53760
    v_mfma_f32_16x16x32_bf16 v[60:63], v[172:175], a[216:219], v[60:63]
    v_mfma_f32_16x16x32_bf16 v[76:79], v[172:175], a[220:223], v[76:79]
    buffer_load_dwordx4 v220, s[28:31], s42 offen lds
    s_bfe_u32 s49, s48, 0x40008
    v_mfma_f32_16x16x32_bf16 v[16:19], v[144:147], a[224:227], v[16:19]
    s_waitcnt lgkmcnt(14)
    ds_read_b64_tr_b16 v[172:173], v213 offset:61440
    s_mul_i32 s42, s49, 229376
    v_mfma_f32_16x16x32_bf16 v[32:35], v[144:147], a[228:231], v[32:35]
    s_add_u32 s42, s42, s59
    ds_read_b64_tr_b16 v[174:175], v213 offset:61952
    s_add_u32 m0, s43, 22528
    v_mfma_f32_16x16x32_bf16 v[48:51], v[144:147], a[232:235], v[48:51]
    v_mfma_f32_16x16x32_bf16 v[64:67], v[144:147], a[236:239], v[64:67]
    v_mfma_f32_16x16x32_bf16 v[24:27], v[148:151], a[224:227], v[24:27]
    buffer_load_dwordx4 v228, s[36:39], s5 offen offset:0 lds
    v_mfma_f32_16x16x32_bf16 v[40:43], v[148:151], a[228:231], v[40:43]
    v_mfma_f32_16x16x32_bf16 v[56:59], v[148:151], a[232:235], v[56:59]
    v_mfma_f32_16x16x32_bf16 v[72:75], v[148:151], a[236:239], v[72:75]
    global_load_dword v235, v240, s[14:15] sc1
    s_waitcnt lgkmcnt(14)
    v_mfma_f32_16x16x32_bf16 v[20:23], v[152:155], a[224:227], v[20:23]
    buffer_load_dwordx4 v229, s[36:39], s5 offen offset:1024 lds
    v_mfma_f32_16x16x32_bf16 v[36:39], v[152:155], a[228:231], v[36:39]
    v_mfma_f32_16x16x32_bf16 v[52:55], v[152:155], a[232:235], v[52:55]
    v_mfma_f32_16x16x32_bf16 v[68:71], v[152:155], a[236:239], v[68:71]
    s_waitcnt vmcnt(13) lgkmcnt(10)
    s_barrier
    v_mfma_f32_16x16x32_bf16 v[28:31], v[156:159], a[224:227], v[28:31]
    s_add_u32 m0, s44, 32768
    ds_read_b64_tr_b16 v[144:145], v212 offset:0
    v_mfma_f32_16x16x32_bf16 v[44:47], v[156:159], a[228:231], v[44:47]
    ds_read_b64_tr_b16 v[146:147], v212 offset:512
    buffer_load_dwordx4 v220, s[28:31], s42 offen lds
    v_mfma_f32_16x16x32_bf16 v[60:63], v[156:159], a[232:235], v[60:63]
    s_add_u32 s42, s42, 57344
    ds_read_b64_tr_b16 v[148:149], v212 offset:8192
    s_add_u32 m0, s44, 34816
    v_mfma_f32_16x16x32_bf16 v[76:79], v[156:159], a[236:239], v[76:79]
    s_waitcnt lgkmcnt(9)
    ds_read_b64_tr_b16 v[150:151], v212 offset:8704
    v_mfma_f32_16x16x32_bf16 v[16:19], v[160:163], a[240:243], v[16:19]
    ds_read_b64_tr_b16 v[152:153], v213 offset:0
    v_mfma_f32_16x16x32_bf16 v[32:35], v[160:163], a[244:247], v[32:35]
    ds_read_b64_tr_b16 v[154:155], v213 offset:512
    buffer_load_dwordx4 v220, s[28:31], s42 offen lds
    v_mfma_f32_16x16x32_bf16 v[48:51], v[160:163], a[248:251], v[48:51]
    s_add_u32 s42, s42, 57344
    ds_read_b64_tr_b16 v[156:157], v213 offset:8192
    s_add_u32 m0, s44, 36864
    v_mfma_f32_16x16x32_bf16 v[64:67], v[160:163], a[252:255], v[64:67]
    s_waitcnt lgkmcnt(11)
    ds_read_b64_tr_b16 v[158:159], v213 offset:8704
    v_mfma_f32_16x16x32_bf16 v[24:27], v[164:167], a[240:243], v[24:27]
    s_barrier
    v_mfma_f32_16x16x32_bf16 v[40:43], v[164:167], a[244:247], v[40:43]
    ds_read_b64_tr_b16 v[160:161], v212 offset:4096
    v_mfma_f32_16x16x32_bf16 v[56:59], v[164:167], a[248:251], v[56:59]
    ds_read_b64_tr_b16 v[162:163], v212 offset:4608
    buffer_load_dwordx4 v220, s[28:31], s42 offen lds
    v_mfma_f32_16x16x32_bf16 v[72:75], v[164:167], a[252:255], v[72:75]
    s_waitcnt lgkmcnt(12)
    s_add_u32 s42, s42, 57344
    s_add_u32 m0, s44, 38912
    v_mfma_f32_16x16x32_bf16 v[20:23], v[168:171], a[240:243], v[20:23]
    ds_read_b64_tr_b16 v[164:165], v212 offset:12288
    v_mfma_f32_16x16x32_bf16 v[36:39], v[168:171], a[244:247], v[36:39]
    ds_read_b64_tr_b16 v[166:167], v212 offset:12800
    v_mfma_f32_16x16x32_bf16 v[52:55], v[168:171], a[248:251], v[52:55]
    s_branch SEG1
.p2align 12
PAD1:
    s_branch PADRET1
    s_nop 0
SEG1:
    buffer_load_dwordx4 v220, s[28:31], s42 offen lds
    s_bfe_u32 s49, s48, 0x4000c
    v_mfma_f32_16x16x32_bf16 v[68:71], v[168:171], a[252:255], v[68:71]
    s_waitcnt lgkmcnt(12)
    s_mul_i32 s42, s49, 229376
    s_add_u32 s42, s42, s59
    v_mfma_f32_16x16x32_bf16 v[28:31], v[172:175], a[240:243], v[28:31]
    s_add_u32 m0, s43, 0
    ds_read_b64_tr_b16 v[168:169], v213 offset:4096
    v_mfma_f32_16x16x32_bf16 v[44:47], v[172:175], a[244:247], v[44:47]
    ds_read_b64_tr_b16 v[170:171], v213 offset:4608
    v_mfma_f32_16x16x32_bf16 v[60:63], v[172:175], a[248:251], v[60:63]
    v_mfma_f32_16x16x32_bf16 v[76:79], v[172:175], a[252:255], v[76:79]
    buffer_load_dwordx4 v226, s[36:39], s6 offen offset:0 lds
    buffer_load_dwordx4 v227, s[36:39], s6 offen offset:1024 lds
    s_add_u32 m0, s43, 2048
    s_nop 0
    buffer_load_dwordx4 v228, s[36:39], s6 offen offset:0 lds
    s_nop 3
    s_nop 0
    v_pk_mul_f32 v[176:177], v[16:17], v[16:17]
    v_pk_mul_f32 v[178:179], v[18:19], v[18:19]
    v_pk_mul_f32 v[180:181], v[20:21], v[20:21]
    v_pk_mul_f32 v[182:183], v[22:23], v[22:23]
    v_pk_fma_f32 v[176:177], v[176:177], v[224:225], v[222:223]
    v_pk_fma_f32 v[178:179], v[178:179], v[224:225], v[222:223]
    v_pk_fma_f32 v[180:181], v[180:181], v[224:225], v[222:223]
    v_pk_fma_f32 v[182:183], v[182:183], v[224:225], v[222:223]
    v_pk_mul_f32 v[176:177], v[176:177], v[16:17]
    v_pk_mul_f32 v[178:179], v[178:179], v[18:19]
    v_pk_mul_f32 v[180:181], v[180:181], v[20:21]
    v_pk_mul_f32 v[182:183], v[182:183], v[22:23]
    v_exp_f32 v176, v176
    v_exp_f32 v177, v177
    v_exp_f32 v178, v178
    v_exp_f32 v179, v179
    v_exp_f32 v180, v180
    v_exp_f32 v181, v181
    v_exp_f32 v182, v182
    buffer_load_dwordx4 v229, s[36:39], s6 offen offset:1024 lds
    s_add_u32 m0, s43, 4096
    v_exp_f32 v183, v183
    v_pk_mul_f32 v[16:17], v[16:17], v[24:25]
    v_pk_mul_f32 v[18:19], v[18:19], v[26:27]
    v_pk_mul_f32 v[20:21], v[20:21], v[28:29]
    v_pk_mul_f32 v[22:23], v[22:23], v[30:31]
    v_pk_add_f32 v[176:177], v[176:177], 1.0 op_sel_hi:[1,0]
    v_pk_add_f32 v[178:179], v[178:179], 1.0 op_sel_hi:[1,0]
    v_pk_add_f32 v[180:181], v[180:181], 1.0 op_sel_hi:[1,0]
    v_pk_add_f32 v[182:183], v[182:183], 1.0 op_sel_hi:[1,0]
    v_rcp_f32 v176, v176
    v_rcp_f32 v177, v177
    v_rcp_f32 v178, v178
    v_rcp_f32 v179, v179
    v_rcp_f32 v180, v180
    v_rcp_f32 v181, v181
    v_rcp_f32 v182, v182
    buffer_load_dwordx4 v226, s[36:39], s7 offen offset:0 lds
    v_rcp_f32 v183, v183
    v_pk_mul_f32 v[16:17], v[16:17], v[176:177]
    v_pk_mul_f32 v[18:19], v[18:19], v[178:179]
    v_pk_mul_f32 v[20:21], v[20:21], v[180:181]
    v_pk_mul_f32 v[22:23], v[22:23], v[182:183]
    v_cvt_pk_bf16_f32 v24, v16, v17
    v_cvt_pk_bf16_f32 v25, v18, v19
    v_cvt_pk_bf16_f32 v26, v20, v21
    v_cvt_pk_bf16_f32 v27, v22, v23
    buffer_store_dwordx4 v[24:27], v221, s[32:35], s0 offen offset:0 sc1
    v_pk_mul_f32 v[184:185], v[32:33], v[32:33]
    v_pk_mul_f32 v[186:187], v[34:35], v[34:35]
    v_pk_mul_f32 v[188:189], v[36:37], v[36:37]
    v_pk_mul_f32 v[190:191], v[38:39], v[38:39]
    v_pk_fma_f32 v[184:185], v[184:185], v[224:225], v[222:223]
    v_pk_fma_f32 v[186:187], v[186:187], v[224:225], v[222:223]
    v_pk_fma_f32 v[188:189], v[188:189], v[224:225], v[222:223]
    v_pk_fma_f32 v[190:191], v[190:191], v[224:225], v[222:223]
    v_pk_mul_f32 v[184:185], v[184:185], v[32:33]
    v_pk_mul_f32 v[186:187], v[186:187], v[34:35]
    v_pk_mul_f32 v[188:189], v[188:189], v[36:37]
    v_pk_mul_f32 v[190:191], v[190:191], v[38:39]
    v_exp_f32 v184, v184
    v_exp_f32 v185, v185
    v_exp_f32 v186, v186
    v_exp_f32 v187, v187
    v_exp_f32 v188, v188
    v_exp_f32 v189, v189
    v_exp_f32 v190, v190
    buffer_load_dwordx4 v227, s[36:39], s7 offen offset:1024 lds
    s_add_u32 m0, s43, 6144
    v_exp_f32 v191, v191
    v_pk_mul_f32 v[32:33], v[32:33], v[40:41]
    v_pk_mul_f32 v[34:35], v[34:35], v[42:43]
    v_pk_mul_f32 v[36:37], v[36:37], v[44:45]
    v_pk_mul_f32 v[38:39], v[38:39], v[46:47]
    v_pk_add_f32 v[184:185], v[184:185], 1.0 op_sel_hi:[1,0]
    v_pk_add_f32 v[186:187], v[186:187], 1.0 op_sel_hi:[1,0]
    v_pk_add_f32 v[188:189], v[188:189], 1.0 op_sel_hi:[1,0]
    v_pk_add_f32 v[190:191], v[190:191], 1.0 op_sel_hi:[1,0]
    v_rcp_f32 v184, v184
    v_rcp_f32 v185, v185
    v_rcp_f32 v186, v186
    v_rcp_f32 v187, v187
    v_rcp_f32 v188, v188
    v_rcp_f32 v189, v189
    v_rcp_f32 v190, v190
    buffer_load_dwordx4 v228, s[36:39], s7 offen offset:0 lds
    v_rcp_f32 v191, v191
    v_pk_mul_f32 v[32:33], v[32:33], v[184:185]
    v_pk_mul_f32 v[34:35], v[34:35], v[186:187]
    v_pk_mul_f32 v[36:37], v[36:37], v[188:189]
    v_pk_mul_f32 v[38:39], v[38:39], v[190:191]
    v_cvt_pk_bf16_f32 v40, v32, v33
    v_cvt_pk_bf16_f32 v41, v34, v35
    v_cvt_pk_bf16_f32 v42, v36, v37
    v_cvt_pk_bf16_f32 v43, v38, v39
    buffer_store_dwordx4 v[40:43], v221, s[32:35], s0 offen offset:2048 sc1
    v_pk_mul_f32 v[176:177], v[48:49], v[48:49]
    v_pk_mul_f32 v[178:179], v[50:51], v[50:51]
    v_pk_mul_f32 v[180:181], v[52:53], v[52:53]
    v_pk_mul_f32 v[182:183], v[54:55], v[54:55]
    v_pk_fma_f32 v[176:177], v[176:177], v[224:225], v[222:223]
    v_pk_fma_f32 v[178:179], v[178:179], v[224:225], v[222:223]
    v_pk_fma_f32 v[180:181], v[180:181], v[224:225], v[222:223]
    v_pk_fma_f32 v[182:183], v[182:183], v[224:225], v[222:223]
    v_pk_mul_f32 v[176:177], v[176:177], v[48:49]
    v_pk_mul_f32 v[178:179], v[178:179], v[50:51]
    v_pk_mul_f32 v[180:181], v[180:181], v[52:53]
    v_pk_mul_f32 v[182:183], v[182:183], v[54:55]
    v_exp_f32 v176, v176
    v_exp_f32 v177, v177
    v_exp_f32 v178, v178
    v_exp_f32 v179, v179
    v_exp_f32 v180, v180
    v_exp_f32 v181, v181
    v_exp_f32 v182, v182
    buffer_load_dwordx4 v229, s[36:39], s7 offen offset:1024 lds
    s_add_u32 m0, s43, 8192
    v_exp_f32 v183, v183
    v_pk_mul_f32 v[48:49], v[48:49], v[56:57]
    v_pk_mul_f32 v[50:51], v[50:51], v[58:59]
    v_pk_mul_f32 v[52:53], v[52:53], v[60:61]
    v_pk_mul_f32 v[54:55], v[54:55], v[62:63]
    v_pk_add_f32 v[176:177], v[176:177], 1.0 op_sel_hi:[1,0]
    v_pk_add_f32 v[178:179], v[178:179], 1.0 op_sel_hi:[1,0]
    v_pk_add_f32 v[180:181], v[180:181], 1.0 op_sel_hi:[1,0]
    v_pk_add_f32 v[182:183], v[182:183], 1.0 op_sel_hi:[1,0]
    v_rcp_f32 v176, v176
    v_rcp_f32 v177, v177
    v_rcp_f32 v178, v178
    v_rcp_f32 v179, v179
    v_rcp_f32 v180, v180
    v_rcp_f32 v181, v181
    v_rcp_f32 v182, v182
    buffer_load_dwordx4 v226, s[36:39], s8 offen offset:0 lds
    v_rcp_f32 v183, v183
    v_pk_mul_f32 v[48:49], v[48:49], v[176:177]
    v_pk_mul_f32 v[50:51], v[50:51], v[178:179]
    v_pk_mul_f32 v[52:53], v[52:53], v[180:181]
    v_pk_mul_f32 v[54:55], v[54:55], v[182:183]
    v_cvt_pk_bf16_f32 v56, v48, v49
    v_cvt_pk_bf16_f32 v57, v50, v51
    v_cvt_pk_bf16_f32 v58, v52, v53
    v_cvt_pk_bf16_f32 v59, v54, v55
    buffer_store_dwordx4 v[56:59], v221, s[32:35], s100 offen offset:0 sc1
    v_pk_mul_f32 v[184:185], v[64:65], v[64:65]
    v_pk_mul_f32 v[186:187], v[66:67], v[66:67]
    v_pk_mul_f32 v[188:189], v[68:69], v[68:69]
    v_pk_mul_f32 v[190:191], v[70:71], v[70:71]
    v_pk_fma_f32 v[184:185], v[184:185], v[224:225], v[222:223]
    v_pk_fma_f32 v[186:187], v[186:187], v[224:225], v[222:223]
    v_pk_fma_f32 v[188:189], v[188:189], v[224:225], v[222:223]
    v_pk_fma_f32 v[190:191], v[190:191], v[224:225], v[222:223]
    v_pk_mul_f32 v[184:185], v[184:185], v[64:65]
    v_pk_mul_f32 v[186:187], v[186:187], v[66:67]
    v_pk_mul_f32 v[188:189], v[188:189], v[68:69]
    v_pk_mul_f32 v[190:191], v[190:191], v[70:71]
    v_exp_f32 v184, v184
    v_exp_f32 v185, v185
    v_exp_f32 v186, v186
    v_exp_f32 v187, v187
    v_exp_f32 v188, v188
    v_exp_f32 v189, v189
    v_exp_f32 v190, v190
    buffer_load_dwordx4 v227, s[36:39], s8 offen offset:1024 lds
    s_add_u32 m0, s43, 10240
    v_exp_f32 v191, v191
    v_pk_mul_f32 v[64:65], v[64:65], v[72:73]
    v_pk_mul_f32 v[66:67], v[66:67], v[74:75]
    v_pk_mul_f32 v[68:69], v[68:69], v[76:77]
    v_pk_mul_f32 v[70:71], v[70:71], v[78:79]
    v_pk_add_f32 v[184:185], v[184:185], 1.0 op_sel_hi:[1,0]
    v_pk_add_f32 v[186:187], v[186:187], 1.0 op_sel_hi:[1,0]
    v_pk_add_f32 v[188:189], v[188:189], 1.0 op_sel_hi:[1,0]
    v_pk_add_f32 v[190:191], v[190:191], 1.0 op_sel_hi:[1,0]
    v_rcp_f32 v184, v184
    v_rcp_f32 v185, v185
    v_rcp_f32 v186, v186
    v_rcp_f32 v187, v187
    v_rcp_f32 v188, v188
    v_rcp_f32 v189, v189
    v_rcp_f32 v190, v190
    buffer_load_dwordx4 v228, s[36:39], s8 offen offset:0 lds
    v_rcp_f32 v191, v191
    v_pk_mul_f32 v[64:65], v[64:65], v[184:185]
    v_pk_mul_f32 v[66:67], v[66:67], v[186:187]
    v_pk_mul_f32 v[68:69], v[68:69], v[188:189]
    v_pk_mul_f32 v[70:71], v[70:71], v[190:191]
    v_cvt_pk_bf16_f32 v72, v64, v65
    v_cvt_pk_bf16_f32 v73, v66, v67
    v_cvt_pk_bf16_f32 v74, v68, v69
    v_cvt_pk_bf16_f32 v75, v70, v71
    buffer_store_dwordx4 v[72:75], v221, s[32:35], s100 offen offset:2048 sc1
    s_waitcnt lgkmcnt(12)
    v_mfma_f32_16x16x32_bf16 v[80:83], v[144:147], a[0:3], 0
    ds_read_b64_tr_b16 v[172:173], v213 offset:12288
    v_mfma_f32_16x16x32_bf16 v[96:99], v[144:147], a[4:7], 0
    ds_read_b64_tr_b16 v[174:175], v213 offset:12800
    v_mfma_f32_16x16x32_bf16 v[112:115], v[144:147], a[8:11], 0
    v_mfma_f32_16x16x32_bf16 v[128:131], v[144:147], a[12:15], 0
    s_waitcnt lgkmcnt(12)
    buffer_load_dwordx4 v229, s[36:39], s8 offen offset:1024 lds
    s_add_u32 m0, s43, 12288
    v_mfma_f32_16x16x32_bf16 v[88:91], v[148:151], a[0:3], 0
    v_mfma_f32_16x16x32_bf16 v[104:107], v[148:151], a[4:7], 0
    v_mfma_f32_16x16x32_bf16 v[120:123], v[148:151], a[8:11], 0
    v_mfma_f32_16x16x32_bf16 v[136:139], v[148:151], a[12:15], 0
    s_waitcnt lgkmcnt(10)
    v_mfma_f32_16x16x32_bf16 v[84:87], v[152:155], a[0:3], 0
    buffer_load_dwordx4 v226, s[36:39], s9 offen offset:0 lds
    v_mfma_f32_16x16x32_bf16 v[100:103], v[152:155], a[4:7], 0
    v_mfma_f32_16x16x32_bf16 v[116:119], v[152:155], a[8:11], 0
    v_mfma_f32_16x16x32_bf16 v[132:135], v[152:155], a[12:15], 0
    s_waitcnt vmcnt(24) lgkmcnt(8)
    s_barrier
    v_mfma_f32_16x16x32_bf16 v[92:95], v[156:159], a[0:3], 0
    ds_read_b64_tr_b16 v[144:145], v212 offset:16384
    buffer_load_dwordx4 v227, s[36:39], s9 offen offset:1024 lds
    v_mfma_f32_16x16x32_bf16 v[108:111], v[156:159], a[4:7], 0
    s_add_u32 m0, s43, 14336
    ds_read_b64_tr_b16 v[146:147], v212 offset:16896
    v_mfma_f32_16x16x32_bf16 v[124:127], v[156:159], a[8:11], 0
    ds_read_b64_tr_b16 v[148:149], v212 offset:24576
    v_mfma_f32_16x16x32_bf16 v[140:143], v[156:159], a[12:15], 0
    s_waitcnt lgkmcnt(9)
    ds_read_b64_tr_b16 v[150:151], v212 offset:25088
    v_mfma_f32_16x16x32_bf16 v[80:83], v[160:163], a[16:19], v[80:83]
    ds_read_b64_tr_b16 v[152:153], v213 offset:16384
    v_mfma_f32_16x16x32_bf16 v[96:99], v[160:163], a[20:23], v[96:99]
    ds_read_b64_tr_b16 v[154:155], v213 offset:16896
    buffer_load_dwordx4 v228, s[36:39], s9 offen offset:0 lds
    v_mfma_f32_16x16x32_bf16 v[112:115], v[160:163], a[24:27], v[112:115]
    ds_read_b64_tr_b16 v[156:157], v213 offset:24576
    v_mfma_f32_16x16x32_bf16 v[128:131], v[160:163], a[28:31], v[128:131]
    s_waitcnt lgkmcnt(11)
    ds_read_b64_tr_b16 v[158:159], v213 offset:25088
    v_mfma_f32_16x16x32_bf16 v[88:91], v[164:167], a[16:19], v[88:91]
    ds_read_b64_tr_b16 v[160:161], v212 offset:20480
    v_mfma_f32_16x16x32_bf16 v[104:107], v[164:167], a[20:23], v[104:107]
    ds_read_b64_tr_b16 v[162:163], v212 offset:20992
    buffer_load_dwordx4 v229, s[36:39], s9 offen offset:1024 lds
    v_mfma_f32_16x16x32_bf16 v[120:123], v[164:167], a[24:27], v[120:123]
    s_add_u32 m0, s44, 49152
    ds_read_b64_tr_b16 a[0:1], v244 offset:16384
    v_mfma_f32_16x16x32_bf16 v[136:139], v[164:167], a[28:31], v[136:139]
    s_waitcnt lgkmcnt(13)
    ds_read_b64_tr_b16 a[4:5], v245 offset:16384
    v_mfma_f32_16x16x32_bf16 v[84:87], v[168:171], a[16:19], v[84:87]
    ds_read_b64_tr_b16 v[164:165], v212 offset:28672
    v_mfma_f32_16x16x32_bf16 v[100:103], v[168:171], a[20:23], v[100:103]
    ds_read_b64_tr_b16 v[166:167], v212 offset:29184
    v_mfma_f32_16x16x32_bf16 v[116:119], v[168:171], a[24:27], v[116:119]
    ds_read_b64_tr_b16 a[8:9], v246 offset:16384
    buffer_load_dwordx4 v220, s[28:31], s42 offen lds
    v_mfma_f32_16x16x32_bf16 v[132:135], v[168:171], a[28:31], v[132:135]
    s_waitcnt lgkmcnt(15)
    ds_read_b64_tr_b16 a[12:13], v247 offset:16384
    s_add_u32 s42, s42, 57344
    v_mfma_f32_16x16x32_bf16 v[92:95], v[172:175], a[16:19], v[92:95]
    s_add_u32 m0, s44, 51200
    ds_read_b64_tr_b16 v[168:169], v213 offset:20480
    v_mfma_f32_16x16x32_bf16 v[108:111], v[172:175], a[20:23], v[108:111]
    ds_read_b64_tr_b16 v[170:171], v213 offset:20992
    v_mfma_f32_16x16x32_bf16 v[124:127], v[172:175], a[24:27], v[124:127]
    ds_read_b64_tr_b16 a[2:3], v244 offset:18432
    buffer_load_dwordx4 v220, s[28:31], s42 offen lds
    v_mfma_f32_16x16x32_bf16 v[140:143], v[172:175], a[28:31], v[140:143]
    s_waitcnt lgkmcnt(15)
    ds_read_b64_tr_b16 a[6:7], v245 offset:18432
    s_add_u32 s42, s42, 57344
    v_mfma_f32_16x16x32_bf16 v[80:83], v[144:147], a[32:35], v[80:83]
    s_add_u32 m0, s44, 53248
    ds_read_b64_tr_b16 v[172:173], v213 offset:28672
    v_mfma_f32_16x16x32_bf16 v[96:99], v[144:147], a[36:39], v[96:99]
    ds_read_b64_tr_b16 v[174:175], v213 offset:29184
    v_mfma_f32_16x16x32_bf16 v[112:115], v[144:147], a[40:43], v[112:115]
    ds_read_b64_tr_b16 a[10:11], v246 offset:18432
    v_mfma_f32_16x16x32_bf16 v[128:131], v[144:147], a[44:47], v[128:131]
    ds_read_b64_tr_b16 a[14:15], v247 offset:18432
    buffer_load_dwordx4 v220, s[28:31], s42 offen lds
    v_mfma_f32_16x16x32_bf16 v[88:91], v[148:151], a[32:35], v[88:91]
    s_add_u32 s42, s42, 57344
    ds_read_b64_tr_b16 a[16:17], v244 offset:20480
    s_add_u32 m0, s44, 55296
    v_mfma_f32_16x16x32_bf16 v[104:107], v[148:151], a[36:39], v[104:107]
    s_waitcnt vmcnt(28)
    v_readfirstlane_b32 s56, v235
    s_cmp_lg_u32 s56, 1
    s_cbranch_scc0 EP_SPIN_X
    s_mov_b32 s51, 0
EP_SPIN:
    global_load_dword v235, v240, s[14:15] sc1
    s_add_u32 s51, s51, 1
    s_waitcnt vmcnt(0)
    s_cmp_gt_u32 s51, 200000
    s_cbranch_scc1 EP_SPIN_X
    v_readfirstlane_b32 s56, v235
    s_cmp_lg_u32 s56, 1
    s_cbranch_scc1 EP_SPIN
EP_SPIN_X:
    v_mfma_f32_16x16x32_bf16 v[120:123], v[148:151], a[40:43], v[120:123]
    ds_read_b64_tr_b16 a[20:21], v245 offset:20480
    v_mfma_f32_16x16x32_bf16 v[136:139], v[148:151], a[44:47], v[136:139]
    s_waitcnt lgkmcnt(15)
    ds_read_b64_tr_b16 a[24:25], v246 offset:20480
    buffer_load_dwordx4 v220, s[28:31], s42 offen lds
    v_mfma_f32_16x16x32_bf16 v[84:87], v[152:155], a[32:35], v[84:87]
    s_bfe_u32 s49, s48, 0x40010
    ds_read_b64_tr_b16 a[28:29], v247 offset:20480
    s_mul_i32 s42, s49, 229376
    v_mfma_f32_16x16x32_bf16 v[100:103], v[152:155], a[36:39], v[100:103]
    s_waitcnt vmcnt(28)
    ds_read_b64_tr_b16 a[18:19], v244 offset:22528
    s_add_u32 s42, s42, s59
    v_mfma_f32_16x16x32_bf16 v[116:119], v[152:155], a[40:43], v[116:119]
    ds_read_b64_tr_b16 a[22:23], v245 offset:22528
    v_mfma_f32_16x16x32_bf16 v[132:135], v[152:155], a[44:47], v[132:135]
    s_waitcnt vmcnt(24)
    s_barrier
    v_mfma_f32_16x16x32_bf16 v[92:95], v[156:159], a[32:35], v[92:95]
    s_add_u32 m0, s44, 0
    ds_read_b64_tr_b16 v[144:145], v212 offset:32768
    buffer_load_dwordx4 v220, s[28:31], s42 offen lds
    v_mfma_f32_16x16x32_bf16 v[108:111], v[156:159], a[36:39], v[108:111]
    s_add_u32 s42, s42, 57344
    ds_read_b64_tr_b16 v[146:147], v212 offset:33280
    s_add_u32 m0, s44, 2048
    v_mfma_f32_16x16x32_bf16 v[124:127], v[156:159], a[40:43], v[124:127]
    ds_read_b64_tr_b16 v[148:149], v212 offset:40960
    v_mfma_f32_16x16x32_bf16 v[140:143], v[156:159], a[44:47], v[140:143]
    ds_read_b64_tr_b16 v[150:151], v212 offset:41472
    v_mfma_f32_16x16x32_bf16 v[80:83], v[160:163], a[48:51], v[80:83]
    ds_read_b64_tr_b16 v[152:153], v213 offset:32768
    buffer_load_dwordx4 v220, s[28:31], s42 offen lds
    v_mfma_f32_16x16x32_bf16 v[96:99], v[160:163], a[52:55], v[96:99]
    s_add_u32 s42, s42, 57344
    ds_read_b64_tr_b16 v[154:155], v213 offset:33280
    s_add_u32 m0, s44, 4096
    v_mfma_f32_16x16x32_bf16 v[112:115], v[160:163], a[56:59], v[112:115]
    ds_read_b64_tr_b16 v[156:157], v213 offset:40960
    v_mfma_f32_16x16x32_bf16 v[128:131], v[160:163], a[60:63], v[128:131]
    s_waitcnt lgkmcnt(15)
    ds_read_b64_tr_b16 v[158:159], v213 offset:41472
    v_mfma_f32_16x16x32_bf16 v[88:91], v[164:167], a[48:51], v[88:91]
    ds_read_b64_tr_b16 v[160:161], v212 offset:36864
    v_mfma_f32_16x16x32_bf16 v[104:107], v[164:167], a[52:55], v[104:107]
    s_mov_b64 exec, 1
    s_waitcnt vmcnt(11)
    buffer_atomic_add v237, v240, s[32:35], s50 offen sc1
    s_mov_b64 exec, -1
    v_mfma_f32_16x16x32_bf16 v[120:123], v[164:167], a[56:59], v[120:123]
    ds_read_b64_tr_b16 v[162:163], v212 offset:37376
    buffer_load_dwordx4 v220, s[28:31], s42 offen lds
    v_mfma_f32_16x16x32_bf16 v[136:139], v[164:167], a[60:63], v[136:139]
    s_add_u32 s42, s42, 57344
    ds_read_b64_tr_b16 a[26:27], v246 offset:22528
    s_add_u32 m0, s44, 6144
    v_mfma_f32_16x16x32_bf16 v[84:87], v[168:171], a[48:51], v[84:87]
    ds_read_b64_tr_b16 v[164:165], v212 offset:45056
    v_mfma_f32_16x16x32_bf16 v[100:103], v[168:171], a[52:55], v[100:103]
    ds_read_b64_tr_b16 v[166:167], v212 offset:45568
    v_mfma_f32_16x16x32_bf16 v[116:119], v[168:171], a[56:59], v[116:119]
    ds_read_b64_tr_b16 a[30:31], v247 offset:22528
    buffer_load_dwordx4 v220, s[28:31], s42 offen lds
    v_mfma_f32_16x16x32_bf16 v[132:135], v[168:171], a[60:63], v[132:135]
    s_bfe_u32 s49, s48, 0x40014
    ds_read_b64_tr_b16 a[32:33], v244 offset:0
    s_mul_i32 s42, s49, 229376
    v_mfma_f32_16x16x32_bf16 v[92:95], v[172:175], a[48:51], v[92:95]
    s_add_u32 s42, s42, s59
    ds_read_b64_tr_b16 v[168:169], v213 offset:36864
    s_add_u32 m0, s43, 16384
    v_mfma_f32_16x16x32_bf16 v[108:111], v[172:175], a[52:55], v[108:111]
    ds_read_b64_tr_b16 v[170:171], v213 offset:37376
    v_mfma_f32_16x16x32_bf16 v[124:127], v[172:175], a[56:59], v[124:127]
    ds_read_b64_tr_b16 a[36:37], v245 offset:0
    v_mfma_f32_16x16x32_bf16 v[140:143], v[172:175], a[60:63], v[140:143]
    s_waitcnt lgkmcnt(15)
    ds_read_b64_tr_b16 a[40:41], v246 offset:0
    buffer_load_dwordx4 v226, s[36:39], s10 offen offset:0 lds
    v_mfma_f32_16x16x32_bf16 v[80:83], v[144:147], a[64:67], v[80:83]
    ds_read_b64_tr_b16 v[172:173], v213 offset:45056
    v_add_u32 v226, 0x10000, v226
    v_mfma_f32_16x16x32_bf16 v[96:99], v[144:147], a[68:71], v[96:99]
    ds_read_b64_tr_b16 v[174:175], v213 offset:45568
    v_mfma_f32_16x16x32_bf16 v[112:115], v[144:147], a[72:75], v[112:115]
    ds_read_b64_tr_b16 a[44:45], v247 offset:0
    v_mfma_f32_16x16x32_bf16 v[128:131], v[144:147], a[76:79], v[128:131]
    s_waitcnt lgkmcnt(15)
    ds_read_b64_tr_b16 a[34:35], v244 offset:2048
    buffer_load_dwordx4 v227, s[36:39], s10 offen offset:1024 lds
    v_mfma_f32_16x16x32_bf16 v[88:91], v[148:151], a[64:67], v[88:91]
    ds_read_b64_tr_b16 a[38:39], v245 offset:2048
    v_add_u32 v227, 0x10000, v227
    v_mfma_f32_16x16x32_bf16 v[104:107], v[148:151], a[68:71], v[104:107]
    s_add_u32 m0, s43, 18432
    ds_read_b64_tr_b16 a[42:43], v246 offset:2048
    v_mfma_f32_16x16x32_bf16 v[120:123], v[148:151], a[72:75], v[120:123]
    ds_read_b64_tr_b16 a[46:47], v247 offset:2048
    v_mfma_f32_16x16x32_bf16 v[136:139], v[148:151], a[76:79], v[136:139]
    ds_read_b64_tr_b16 a[48:49], v244 offset:4096
    v_mfma_f32_16x16x32_bf16 v[84:87], v[152:155], a[64:67], v[84:87]
    ds_read_b64_tr_b16 a[52:53], v245 offset:4096
    buffer_load_dwordx4 v228, s[36:39], s10 offen offset:0 lds
    v_mfma_f32_16x16x32_bf16 v[100:103], v[152:155], a[68:71], v[100:103]
    ds_read_b64_tr_b16 a[56:57], v246 offset:4096
    v_add_u32 v228, 0x10000, v228
    v_mfma_f32_16x16x32_bf16 v[116:119], v[152:155], a[72:75], v[116:119]
    ds_read_b64_tr_b16 a[60:61], v247 offset:4096
    v_mfma_f32_16x16x32_bf16 v[132:135], v[152:155], a[76:79], v[132:135]
    s_waitcnt vmcnt(8) lgkmcnt(15)
    s_barrier
    v_mfma_f32_16x16x32_bf16 v[92:95], v[156:159], a[64:67], v[92:95]
    ds_read_b64_tr_b16 v[144:145], v212 offset:49152
    buffer_load_dwordx4 v229, s[36:39], s10 offen offset:1024 lds
    v_mfma_f32_16x16x32_bf16 v[108:111], v[156:159], a[68:71], v[108:111]
    ds_read_b64_tr_b16 v[146:147], v212 offset:49664
    v_add_u32 v229, 0x10000, v229
    v_mfma_f32_16x16x32_bf16 v[124:127], v[156:159], a[72:75], v[124:127]
    s_add_u32 m0, s43, 20480
    ds_read_b64_tr_b16 v[148:149], v212 offset:57344
    v_mfma_f32_16x16x32_bf16 v[140:143], v[156:159], a[76:79], v[140:143]
    ds_read_b64_tr_b16 v[150:151], v212 offset:57856
    v_mfma_f32_16x16x32_bf16 v[80:83], v[160:163], a[80:83], v[80:83]
    ds_read_b64_tr_b16 v[152:153], v213 offset:49152
    v_mfma_f32_16x16x32_bf16 v[96:99], v[160:163], a[84:87], v[96:99]
    ds_read_b64_tr_b16 v[154:155], v213 offset:49664
    buffer_load_dwordx4 v226, s[36:39], s4 offen offset:0 lds
    v_mfma_f32_16x16x32_bf16 v[112:115], v[160:163], a[88:91], v[112:115]
    ds_read_b64_tr_b16 v[156:157], v213 offset:57344
    v_mfma_f32_16x16x32_bf16 v[128:131], v[160:163], a[92:95], v[128:131]
    ds_read_b64_tr_b16 v[158:159], v213 offset:57856
    v_mfma_f32_16x16x32_bf16 v[88:91], v[164:167], a[80:83], v[88:91]
    ds_read_b64_tr_b16 v[160:161], v212 offset:53248
    v_mfma_f32_16x16x32_bf16 v[104:107], v[164:167], a[84:87], v[104:107]
    ds_read_b64_tr_b16 v[162:163], v212 offset:53760
    buffer_load_dwordx4 v227, s[36:39], s4 offen offset:1024 lds
    v_mfma_f32_16x16x32_bf16 v[120:123], v[164:167], a[88:91], v[120:123]
    s_add_u32 m0, s44, 16384
    ds_read_b64_tr_b16 a[50:51], v244 offset:6144
    v_mfma_f32_16x16x32_bf16 v[136:139], v[164:167], a[92:95], v[136:139]
    s_waitcnt lgkmcnt(15)
    ds_read_b64_tr_b16 a[54:55], v245 offset:6144
    v_mfma_f32_16x16x32_bf16 v[84:87], v[168:171], a[80:83], v[84:87]
    ds_read_b64_tr_b16 v[164:165], v212 offset:61440
    v_mfma_f32_16x16x32_bf16 v[100:103], v[168:171], a[84:87], v[100:103]
    ds_read_b64_tr_b16 v[166:167], v212 offset:61952
    v_mfma_f32_16x16x32_bf16 v[116:119], v[168:171], a[88:91], v[116:119]
    ds_read_b64_tr_b16 a[58:59], v246 offset:6144
    buffer_load_dwordx4 v220, s[28:31], s42 offen lds
    v_mfma_f32_16x16x32_bf16 v[132:135], v[168:171], a[92:95], v[132:135]
    s_add_u32 s42, s42, 57344
    ds_read_b64_tr_b16 a[62:63], v247 offset:6144
    s_add_u32 m0, s44, 18432
    v_mfma_f32_16x16x32_bf16 v[92:95], v[172:175], a[80:83], v[92:95]
    ds_read_b64_tr_b16 v[168:169], v213 offset:53248
    v_mfma_f32_16x16x32_bf16 v[108:111], v[172:175], a[84:87], v[108:111]
    ds_read_b64_tr_b16 v[170:171], v213 offset:53760
    v_mfma_f32_16x16x32_bf16 v[124:127], v[172:175], a[88:91], v[124:127]
    ds_read_b64_tr_b16 a[64:65], v244 offset:8192
    buffer_load_dwordx4 v220, s[28:31], s42 offen lds
    v_mfma_f32_16x16x32_bf16 v[140:143], v[172:175], a[92:95], v[140:143]
    s_waitcnt lgkmcnt(15)
    ds_read_b64_tr_b16 a[68:69], v245 offset:8192
    s_add_u32 s42, s42, 57344
    v_mfma_f32_16x16x32_bf16 v[80:83], v[144:147], a[96:99], v[80:83]
    s_add_u32 m0, s44, 20480
    ds_read_b64_tr_b16 v[172:173], v213 offset:61440
    v_mfma_f32_16x16x32_bf16 v[96:99], v[144:147], a[100:103], v[96:99]
    ds_read_b64_tr_b16 v[174:175], v213 offset:61952
    v_mfma_f32_16x16x32_bf16 v[112:115], v[144:147], a[104:107], v[112:115]
    ds_read_b64_tr_b16 a[72:73], v246 offset:8192
    v_mfma_f32_16x16x32_bf16 v[128:131], v[144:147], a[108:111], v[128:131]
    ds_read_b64_tr_b16 a[76:77], v247 offset:8192
    buffer_load_dwordx4 v220, s[28:31], s42 offen lds
    v_mfma_f32_16x16x32_bf16 v[88:91], v[148:151], a[96:99], v[88:91]
    s_add_u32 s42, s42, 57344
    ds_read_b64_tr_b16 a[66:67], v244 offset:10240
    s_add_u32 m0, s44, 22528
    v_mfma_f32_16x16x32_bf16 v[104:107], v[148:151], a[100:103], v[104:107]
    ds_read_b64_tr_b16 a[70:71], v245 offset:10240
    v_mfma_f32_16x16x32_bf16 v[120:123], v[148:151], a[104:107], v[120:123]
    ds_read_b64_tr_b16 a[74:75], v246 offset:10240
    v_mfma_f32_16x16x32_bf16 v[136:139], v[148:151], a[108:111], v[136:139]
    s_waitcnt lgkmcnt(15)
    ds_read_b64_tr_b16 a[78:79], v247 offset:10240
    buffer_load_dwordx4 v220, s[28:31], s42 offen lds
    v_mfma_f32_16x16x32_bf16 v[84:87], v[152:155], a[96:99], v[84:87]
    s_bfe_u32 s49, s48, 0x40018
    ds_read_b64_tr_b16 a[80:81], v244 offset:12288
    s_mul_i32 s42, s49, 229376
    v_mfma_f32_16x16x32_bf16 v[100:103], v[152:155], a[100:103], v[100:103]
    s_add_u32 s42, s42, s59
    ds_read_b64_tr_b16 a[84:85], v245 offset:12288
    s_add_u32 m0, s43, 22528
    v_mfma_f32_16x16x32_bf16 v[116:119], v[152:155], a[104:107], v[116:119]
    ds_read_b64_tr_b16 a[88:89], v246 offset:12288
    v_mfma_f32_16x16x32_bf16 v[132:135], v[152:155], a[108:111], v[132:135]
    s_waitcnt vmcnt(10)
    s_barrier
    v_mfma_f32_16x16x32_bf16 v[92:95], v[156:159], a[96:99], v[92:95]
    ds_read_b64_tr_b16 v[144:145], v212 offset:0
    buffer_load_dwordx4 v228, s[36:39], s4 offen offset:0 lds
    v_mfma_f32_16x16x32_bf16 v[108:111], v[156:159], a[100:103], v[108:111]
    ds_read_b64_tr_b16 v[146:147], v212 offset:512
    v_mfma_f32_16x16x32_bf16 v[124:127], v[156:159], a[104:107], v[124:127]
    ds_read_b64_tr_b16 v[148:149], v212 offset:8192
    v_mfma_f32_16x16x32_bf16 v[140:143], v[156:159], a[108:111], v[140:143]
    ds_read_b64_tr_b16 v[150:151], v212 offset:8704
    v_mfma_f32_16x16x32_bf16 v[80:83], v[160:163], a[112:115], v[80:83]
    ds_read_b64_tr_b16 v[152:153], v213 offset:0
    buffer_load_dwordx4 v229, s[36:39], s4 offen offset:1024 lds
    v_mfma_f32_16x16x32_bf16 v[96:99], v[160:163], a[116:119], v[96:99]
    s_add_u32 m0, s44, 32768
    ds_read_b64_tr_b16 v[154:155], v213 offset:512
    v_mfma_f32_16x16x32_bf16 v[112:115], v[160:163], a[120:123], v[112:115]
    ds_read_b64_tr_b16 v[156:157], v213 offset:8192
    v_mfma_f32_16x16x32_bf16 v[128:131], v[160:163], a[124:127], v[128:131]
    s_waitcnt lgkmcnt(15)
    ds_read_b64_tr_b16 v[158:159], v213 offset:8704
    v_mfma_f32_16x16x32_bf16 v[88:91], v[164:167], a[112:115], v[88:91]
    ds_read_b64_tr_b16 v[160:161], v212 offset:4096
    v_mfma_f32_16x16x32_bf16 v[104:107], v[164:167], a[116:119], v[104:107]
    ds_read_b64_tr_b16 v[162:163], v212 offset:4608
    buffer_load_dwordx4 v220, s[28:31], s42 offen lds
    v_mfma_f32_16x16x32_bf16 v[120:123], v[164:167], a[120:123], v[120:123]
    s_add_u32 s42, s42, 57344
    ds_read_b64_tr_b16 a[92:93], v247 offset:12288
    s_add_u32 m0, s44, 34816
    v_mfma_f32_16x16x32_bf16 v[136:139], v[164:167], a[124:127], v[136:139]
    ds_read_b64_tr_b16 a[82:83], v244 offset:14336
    v_mfma_f32_16x16x32_bf16 v[84:87], v[168:171], a[112:115], v[84:87]
    ds_read_b64_tr_b16 v[164:165], v212 offset:12288
    v_mfma_f32_16x16x32_bf16 v[100:103], v[168:171], a[116:119], v[100:103]
    ds_read_b64_tr_b16 v[166:167], v212 offset:12800
    buffer_load_dwordx4 v220, s[28:31], s42 offen lds
    v_mfma_f32_16x16x32_bf16 v[116:119], v[168:171], a[120:123], v[116:119]
    s_add_u32 s42, s42, 57344
    ds_read_b64_tr_b16 a[86:87], v245 offset:14336
    s_add_u32 m0, s44, 36864
    v_mfma_f32_16x16x32_bf16 v[132:135], v[168:171], a[124:127], v[132:135]
    ds_read_b64_tr_b16 a[90:91], v246 offset:14336
    v_mfma_f32_16x16x32_bf16 v[92:95], v[172:175], a[112:115], v[92:95]
    ds_read_b64_tr_b16 v[168:169], v213 offset:4096
    v_mfma_f32_16x16x32_bf16 v[108:111], v[172:175], a[116:119], v[108:111]
    ds_read_b64_tr_b16 v[170:171], v213 offset:4608
    v_mfma_f32_16x16x32_bf16 v[124:127], v[172:175], a[120:123], v[124:127]
    ds_read_b64_tr_b16 a[94:95], v247 offset:14336
    buffer_load_dwordx4 v220, s[28:31], s42 offen lds
    v_mfma_f32_16x16x32_bf16 v[140:143], v[172:175], a[124:127], v[140:143]
    s_branch SEG2
.p2align 12
PAD2:
    s_branch PADRET2
    s_nop 0
SEG2:
    s_waitcnt lgkmcnt(15)
    s_add_u32 s42, s42, 57344
    s_add_u32 m0, s44, 38912
    v_mfma_f32_16x16x32_bf16 v[80:83], v[144:147], a[128:131], v[80:83]
    ds_read_b64_tr_b16 v[172:173], v213 offset:12288
    v_mfma_f32_16x16x32_bf16 v[96:99], v[144:147], a[132:135], v[96:99]
    ds_read_b64_tr_b16 v[174:175], v213 offset:12800
    v_mfma_f32_16x16x32_bf16 v[112:115], v[144:147], a[136:139], v[112:115]
    buffer_load_dwordx4 v220, s[28:31], s42 offen lds
    s_bfe_u32 s49, s48, 0x4001c
    v_mfma_f32_16x16x32_bf16 v[128:131], v[144:147], a[140:143], v[128:131]
    s_mul_i32 s42, s49, 229376
    s_add_u32 s42, s42, s59
    s_add_u32 m0, s43, 0
    v_mfma_f32_16x16x32_bf16 v[88:91], v[148:151], a[128:131], v[88:91]
    v_mfma_f32_16x16x32_bf16 v[104:107], v[148:151], a[132:135], v[104:107]
    v_mfma_f32_16x16x32_bf16 v[120:123], v[148:151], a[136:139], v[120:123]
    v_mfma_f32_16x16x32_bf16 v[136:139], v[148:151], a[140:143], v[136:139]
    s_waitcnt lgkmcnt(15)
    buffer_load_dwordx4 v226, s[36:39], s5 offen offset:0 lds
    v_mfma_f32_16x16x32_bf16 v[84:87], v[152:155], a[128:131], v[84:87]
    v_mfma_f32_16x16x32_bf16 v[100:103], v[152:155], a[132:135], v[100:103]
    v_mfma_f32_16x16x32_bf16 v[116:119], v[152:155], a[136:139], v[116:119]
    v_mfma_f32_16x16x32_bf16 v[132:135], v[152:155], a[140:143], v[132:135]
    s_waitcnt vmcnt(7) lgkmcnt(13)
    s_barrier
    v_mfma_f32_16x16x32_bf16 v[92:95], v[156:159], a[128:131], v[92:95]
    ds_read_b64_tr_b16 v[144:145], v212 offset:16384
    buffer_load_dwordx4 v227, s[36:39], s5 offen offset:1024 lds
    v_mfma_f32_16x16x32_bf16 v[108:111], v[156:159], a[132:135], v[108:111]
    s_add_u32 m0, s43, 2048
    ds_read_b64_tr_b16 v[146:147], v212 offset:16896
    v_mfma_f32_16x16x32_bf16 v[124:127], v[156:159], a[136:139], v[124:127]
    ds_read_b64_tr_b16 v[148:149], v212 offset:24576
    v_mfma_f32_16x16x32_bf16 v[140:143], v[156:159], a[140:143], v[140:143]
    s_waitcnt lgkmcnt(14)
    ds_read_b64_tr_b16 v[150:151], v212 offset:25088
    v_mfma_f32_16x16x32_bf16 v[80:83], v[160:163], a[144:147], v[80:83]
    ds_read_b64_tr_b16 v[152:153], v213 offset:16384
    v_mfma_f32_16x16x32_bf16 v[96:99], v[160:163], a[148:151], v[96:99]
    ds_read_b64_tr_b16 v[154:155], v213 offset:16896
    buffer_load_dwordx4 v228, s[36:39], s5 offen offset:0 lds
    v_mfma_f32_16x16x32_bf16 v[112:115], v[160:163], a[152:155], v[112:115]
    ds_read_b64_tr_b16 v[156:157], v213 offset:24576
    v_mfma_f32_16x16x32_bf16 v[128:131], v[160:163], a[156:159], v[128:131]
    s_waitcnt lgkmcnt(14)
    ds_read_b64_tr_b16 v[158:159], v213 offset:25088
    v_mfma_f32_16x16x32_bf16 v[88:91], v[164:167], a[144:147], v[88:91]
    ds_read_b64_tr_b16 v[160:161], v212 offset:20480
    v_mfma_f32_16x16x32_bf16 v[104:107], v[164:167], a[148:151], v[104:107]
    ds_read_b64_tr_b16 v[162:163], v212 offset:20992
    buffer_load_dwordx4 v229, s[36:39], s5 offen offset:1024 lds
    v_mfma_f32_16x16x32_bf16 v[120:123], v[164:167], a[152:155], v[120:123]
    s_add_u32 m0, s44, 49152
    ds_read_b64_tr_b16 a[96:97], v244 offset:16384
    v_mfma_f32_16x16x32_bf16 v[136:139], v[164:167], a[156:159], v[136:139]
    s_waitcnt lgkmcnt(14)
    ds_read_b64_tr_b16 a[100:101], v245 offset:16384
    v_mfma_f32_16x16x32_bf16 v[84:87], v[168:171], a[144:147], v[84:87]
    ds_read_b64_tr_b16 v[164:165], v212 offset:28672
    v_mfma_f32_16x16x32_bf16 v[100:103], v[168:171], a[148:151], v[100:103]
    ds_read_b64_tr_b16 v[166:167], v212 offset:29184
    v_mfma_f32_16x16x32_bf16 v[116:119], v[168:171], a[152:155], v[116:119]
    ds_read_b64_tr_b16 a[104:105], v246 offset:16384
    buffer_load_dwordx4 v220, s[28:31], s42 offen lds
    v_mfma_f32_16x16x32_bf16 v[132:135], v[168:171], a[156:159], v[132:135]
    s_waitcnt lgkmcnt(15)
    ds_read_b64_tr_b16 a[108:109], v247 offset:16384
    s_add_u32 s42, s42, 57344
    v_mfma_f32_16x16x32_bf16 v[92:95], v[172:175], a[144:147], v[92:95]
    s_add_u32 m0, s44, 51200
    ds_read_b64_tr_b16 v[168:169], v213 offset:20480
    v_mfma_f32_16x16x32_bf16 v[108:111], v[172:175], a[148:151], v[108:111]
    ds_read_b64_tr_b16 v[170:171], v213 offset:20992
    v_mfma_f32_16x16x32_bf16 v[124:127], v[172:175], a[152:155], v[124:127]
    ds_read_b64_tr_b16 a[98:99], v244 offset:18432
    buffer_load_dwordx4 v220, s[28:31], s42 offen lds
    v_mfma_f32_16x16x32_bf16 v[140:143], v[172:175], a[156:159], v[140:143]
    s_waitcnt lgkmcnt(15)
    ds_read_b64_tr_b16 a[102:103], v245 offset:18432
    s_add_u32 s42, s42, 57344
    v_mfma_f32_16x16x32_bf16 v[80:83], v[144:147], a[160:163], v[80:83]
    s_add_u32 m0, s44, 53248
    ds_read_b64_tr_b16 v[172:173], v213 offset:28672
    v_mfma_f32_16x16x32_bf16 v[96:99], v[144:147], a[164:167], v[96:99]
    ds_read_b64_tr_b16 v[174:175], v213 offset:29184
    v_mfma_f32_16x16x32_bf16 v[112:115], v[144:147], a[168:171], v[112:115]
    ds_read_b64_tr_b16 a[106:107], v246 offset:18432
    buffer_load_dwordx4 v220, s[28:31], s42 offen lds
    v_mfma_f32_16x16x32_bf16 v[128:131], v[144:147], a[172:175], v[128:131]
    s_add_u32 s42, s42, 57344
    ds_read_b64_tr_b16 a[110:111], v247 offset:18432
    s_add_u32 m0, s44, 55296
    v_mfma_f32_16x16x32_bf16 v[88:91], v[148:151], a[160:163], v[88:91]
    s_load_dword s54, s[52:53], 0x0 glc
    ds_read_b64_tr_b16 a[112:113], v244 offset:20480
    v_mfma_f32_16x16x32_bf16 v[104:107], v[148:151], a[164:167], v[104:107]
    ds_read_b64_tr_b16 a[116:117], v245 offset:20480
    v_mfma_f32_16x16x32_bf16 v[120:123], v[148:151], a[168:171], v[120:123]
    ds_read_b64_tr_b16 a[120:121], v246 offset:20480
    buffer_load_dwordx4 v220, s[28:31], s42 offen lds
    v_mfma_f32_16x16x32_bf16 v[136:139], v[148:151], a[172:175], v[136:139]
    s_waitcnt lgkmcnt(15)
    ds_read_b64_tr_b16 a[124:125], v247 offset:20480
    s_add_u32 m0, s43, 4096
    v_mfma_f32_16x16x32_bf16 v[84:87], v[152:155], a[160:163], v[84:87]
    v_mfma_f32_16x16x32_bf16 v[100:103], v[152:155], a[164:167], v[100:103]
    v_mfma_f32_16x16x32_bf16 v[116:119], v[152:155], a[168:171], v[116:119]
    buffer_load_dwordx4 v226, s[36:39], s6 offen offset:0 lds
    v_mfma_f32_16x16x32_bf16 v[132:135], v[152:155], a[172:175], v[132:135]
    s_waitcnt vmcnt(9)
    s_barrier
    v_mfma_f32_16x16x32_bf16 v[92:95], v[156:159], a[160:163], v[92:95]
    ds_read_b64_tr_b16 v[144:145], v212 offset:32768
    v_mfma_f32_16x16x32_bf16 v[108:111], v[156:159], a[164:167], v[108:111]
    ds_read_b64_tr_b16 v[146:147], v212 offset:33280
    v_mfma_f32_16x16x32_bf16 v[124:127], v[156:159], a[168:171], v[124:127]
    ds_read_b64_tr_b16 v[148:149], v212 offset:40960
    buffer_load_dwordx4 v227, s[36:39], s6 offen offset:1024 lds
    v_mfma_f32_16x16x32_bf16 v[140:143], v[156:159], a[172:175], v[140:143]
    s_add_u32 m0, s43, 6144
    ds_read_b64_tr_b16 v[150:151], v212 offset:41472
    v_mfma_f32_16x16x32_bf16 v[80:83], v[160:163], a[176:179], v[80:83]
    ds_read_b64_tr_b16 v[152:153], v213 offset:32768
    v_mfma_f32_16x16x32_bf16 v[96:99], v[160:163], a[180:183], v[96:99]
    ds_read_b64_tr_b16 v[154:155], v213 offset:33280
    v_mfma_f32_16x16x32_bf16 v[112:115], v[160:163], a[184:187], v[112:115]
    ds_read_b64_tr_b16 v[156:157], v213 offset:40960
    buffer_load_dwordx4 v228, s[36:39], s6 offen offset:0 lds
    v_mfma_f32_16x16x32_bf16 v[128:131], v[160:163], a[188:191], v[128:131]
    s_waitcnt lgkmcnt(15)
    ds_read_b64_tr_b16 v[158:159], v213 offset:41472
    v_mfma_f32_16x16x32_bf16 v[88:91], v[164:167], a[176:179], v[88:91]
    ds_read_b64_tr_b16 v[160:161], v212 offset:36864
    v_mfma_f32_16x16x32_bf16 v[104:107], v[164:167], a[180:183], v[104:107]
    ds_read_b64_tr_b16 v[162:163], v212 offset:37376
    v_mfma_f32_16x16x32_bf16 v[120:123], v[164:167], a[184:187], v[120:123]
    ds_read_b64_tr_b16 a[114:115], v244 offset:22528
    buffer_load_dwordx4 v229, s[36:39], s6 offen offset:1024 lds
    v_mfma_f32_16x16x32_bf16 v[136:139], v[164:167], a[188:191], v[136:139]
    s_add_u32 m0, s43, 8192
    ds_read_b64_tr_b16 a[118:119], v245 offset:22528
    v_mfma_f32_16x16x32_bf16 v[84:87], v[168:171], a[176:179], v[84:87]
    ds_read_b64_tr_b16 v[164:165], v212 offset:45056
    v_mfma_f32_16x16x32_bf16 v[100:103], v[168:171], a[180:183], v[100:103]
    ds_read_b64_tr_b16 v[166:167], v212 offset:45568
    v_mfma_f32_16x16x32_bf16 v[116:119], v[168:171], a[184:187], v[116:119]
    ds_read_b64_tr_b16 a[122:123], v246 offset:22528
    buffer_load_dwordx4 v226, s[36:39], s7 offen offset:0 lds
    v_mfma_f32_16x16x32_bf16 v[132:135], v[168:171], a[188:191], v[132:135]
    s_waitcnt lgkmcnt(15)
    ds_read_b64_tr_b16 a[126:127], v247 offset:22528
    v_mfma_f32_16x16x32_bf16 v[92:95], v[172:175], a[176:179], v[92:95]
    ds_read_b64_tr_b16 v[168:169], v213 offset:36864
    v_mfma_f32_16x16x32_bf16 v[108:111], v[172:175], a[180:183], v[108:111]
    ds_read_b64_tr_b16 v[170:171], v213 offset:37376
    v_mfma_f32_16x16x32_bf16 v[124:127], v[172:175], a[184:187], v[124:127]
    buffer_load_dwordx4 v227, s[36:39], s7 offen offset:1024 lds
    s_add_u32 m0, s43, 10240
    v_mfma_f32_16x16x32_bf16 v[140:143], v[172:175], a[188:191], v[140:143]
    s_waitcnt lgkmcnt(15)
    v_mfma_f32_16x16x32_bf16 v[80:83], v[144:147], a[192:195], v[80:83]
    ds_read_b64_tr_b16 v[172:173], v213 offset:45056
    v_mfma_f32_16x16x32_bf16 v[96:99], v[144:147], a[196:199], v[96:99]
    ds_read_b64_tr_b16 v[174:175], v213 offset:45568
    v_mfma_f32_16x16x32_bf16 v[112:115], v[144:147], a[200:203], v[112:115]
    buffer_load_dwordx4 v228, s[36:39], s7 offen offset:0 lds
    v_mfma_f32_16x16x32_bf16 v[128:131], v[144:147], a[204:207], v[128:131]
    s_waitcnt lgkmcnt(15)
    v_mfma_f32_16x16x32_bf16 v[88:91], v[148:151], a[192:195], v[88:91]
    v_mfma_f32_16x16x32_bf16 v[104:107], v[148:151], a[196:199], v[104:107]
    v_mfma_f32_16x16x32_bf16 v[120:123], v[148:151], a[200:203], v[120:123]
    buffer_load_dwordx4 v229, s[36:39], s7 offen offset:1024 lds
    s_add_u32 m0, s43, 12288
    v_mfma_f32_16x16x32_bf16 v[136:139], v[148:151], a[204:207], v[136:139]
    s_waitcnt vmcnt(14) lgkmcnt(14)
    ds_read_b64_tr_b16 a[128:129], v244 offset:0
    v_mfma_f32_16x16x32_bf16 v[84:87], v[152:155], a[192:195], v[84:87]
    ds_read_b64_tr_b16 a[132:133], v245 offset:0
    v_mfma_f32_16x16x32_bf16 v[100:103], v[152:155], a[196:199], v[100:103]
    ds_read_b64_tr_b16 a[136:137], v246 offset:0
    v_mfma_f32_16x16x32_bf16 v[116:119], v[152:155], a[200:203], v[116:119]
    ds_read_b64_tr_b16 a[140:141], v247 offset:0
    buffer_load_dwordx4 v226, s[36:39], s8 offen offset:0 lds
    v_mfma_f32_16x16x32_bf16 v[132:135], v[152:155], a[204:207], v[132:135]
    s_waitcnt vmcnt(9) lgkmcnt(15)
    s_barrier
    v_mfma_f32_16x16x32_bf16 v[92:95], v[156:159], a[192:195], v[92:95]
    ds_read_b64_tr_b16 v[144:145], v212 offset:49152
    v_mfma_f32_16x16x32_bf16 v[108:111], v[156:159], a[196:199], v[108:111]
    ds_read_b64_tr_b16 v[146:147], v212 offset:49664
    v_mfma_f32_16x16x32_bf16 v[124:127], v[156:159], a[200:203], v[124:127]
    ds_read_b64_tr_b16 v[148:149], v212 offset:57344
    buffer_load_dwordx4 v227, s[36:39], s8 offen offset:1024 lds
    v_mfma_f32_16x16x32_bf16 v[140:143], v[156:159], a[204:207], v[140:143]
    s_waitcnt lgkmcnt(15)
    ds_read_b64_tr_b16 v[150:151], v212 offset:57856
    s_add_u32 m0, s43, 14336
    v_mfma_f32_16x16x32_bf16 v[80:83], v[160:163], a[208:211], v[80:83]
    ds_read_b64_tr_b16 v[152:153], v213 offset:49152
    v_mfma_f32_16x16x32_bf16 v[96:99], v[160:163], a[212:215], v[96:99]
    ds_read_b64_tr_b16 v[154:155], v213 offset:49664
    v_mfma_f32_16x16x32_bf16 v[112:115], v[160:163], a[216:219], v[112:115]
    ds_read_b64_tr_b16 v[156:157], v213 offset:57344
    buffer_load_dwordx4 v228, s[36:39], s8 offen offset:0 lds
    v_mfma_f32_16x16x32_bf16 v[128:131], v[160:163], a[220:223], v[128:131]
    s_waitcnt lgkmcnt(15)
    ds_read_b64_tr_b16 v[158:159], v213 offset:57856
    v_mfma_f32_16x16x32_bf16 v[88:91], v[164:167], a[208:211], v[88:91]
    ds_read_b64_tr_b16 v[160:161], v212 offset:53248
    v_mfma_f32_16x16x32_bf16 v[104:107], v[164:167], a[212:215], v[104:107]
    ds_read_b64_tr_b16 v[162:163], v212 offset:53760
    v_mfma_f32_16x16x32_bf16 v[120:123], v[164:167], a[216:219], v[120:123]
    ds_read_b64_tr_b16 a[130:131], v244 offset:2048
    buffer_load_dwordx4 v229, s[36:39], s8 offen offset:1024 lds
    v_mfma_f32_16x16x32_bf16 v[136:139], v[164:167], a[220:223], v[136:139]
    s_waitcnt lgkmcnt(15)
    ds_read_b64_tr_b16 a[134:135], v245 offset:2048
    s_add_u32 m0, s43, 16384
    v_mfma_f32_16x16x32_bf16 v[84:87], v[168:171], a[208:211], v[84:87]
    ds_read_b64_tr_b16 v[164:165], v212 offset:61440
    v_mfma_f32_16x16x32_bf16 v[100:103], v[168:171], a[212:215], v[100:103]
    ds_read_b64_tr_b16 v[166:167], v212 offset:61952
    v_mfma_f32_16x16x32_bf16 v[116:119], v[168:171], a[216:219], v[116:119]
    ds_read_b64_tr_b16 a[138:139], v246 offset:2048
    buffer_load_dwordx4 v226, s[36:39], s9 offen offset:0 lds
    v_mfma_f32_16x16x32_bf16 v[132:135], v[168:171], a[220:223], v[132:135]
    ds_read_b64_tr_b16 a[142:143], v247 offset:2048
    v_mfma_f32_16x16x32_bf16 v[92:95], v[172:175], a[208:211], v[92:95]
    ds_read_b64_tr_b16 v[168:169], v213 offset:53248
    v_mfma_f32_16x16x32_bf16 v[108:111], v[172:175], a[212:215], v[108:111]
    ds_read_b64_tr_b16 v[170:171], v213 offset:53760
    v_mfma_f32_16x16x32_bf16 v[124:127], v[172:175], a[216:219], v[124:127]
    s_waitcnt vmcnt(11) lgkmcnt(14)
    ds_read_b64_tr_b16 a[144:145], v244 offset:4096
    buffer_load_dwordx4 v227, s[36:39], s9 offen offset:1024 lds
    v_mfma_f32_16x16x32_bf16 v[140:143], v[172:175], a[220:223], v[140:143]
    s_add_u32 m0, s43, 18432
    ds_read_b64_tr_b16 a[148:149], v245 offset:4096
    v_mfma_f32_16x16x32_bf16 v[80:83], v[144:147], a[224:227], v[80:83]
    ds_read_b64_tr_b16 v[172:173], v213 offset:61440
    v_mfma_f32_16x16x32_bf16 v[96:99], v[144:147], a[228:231], v[96:99]
    ds_read_b64_tr_b16 v[174:175], v213 offset:61952
    v_mfma_f32_16x16x32_bf16 v[88:91], v[148:151], a[224:227], v[88:91]
    ds_read_b64_tr_b16 v[144:145], v212 offset:49152
    buffer_load_dwordx4 v228, s[36:39], s9 offen offset:0 lds
    v_mfma_f32_16x16x32_bf16 v[104:107], v[148:151], a[228:231], v[104:107]
    s_waitcnt lgkmcnt(15)
    ds_read_b64_tr_b16 v[146:147], v212 offset:49664
    v_mfma_f32_16x16x32_bf16 v[84:87], v[152:155], a[224:227], v[84:87]
    ds_read_b64_tr_b16 v[148:149], v212 offset:57344
    v_mfma_f32_16x16x32_bf16 v[100:103], v[152:155], a[228:231], v[100:103]
    ds_read_b64_tr_b16 v[150:151], v212 offset:57856
    v_mfma_f32_16x16x32_bf16 v[92:95], v[156:159], a[224:227], v[92:95]
    ds_read_b64_tr_b16 v[152:153], v213 offset:49152
    buffer_load_dwordx4 v229, s[36:39], s9 offen offset:1024 lds
    v_mfma_f32_16x16x32_bf16 v[108:111], v[156:159], a[228:231], v[108:111]
    s_waitcnt lgkmcnt(13)
    ds_read_b64_tr_b16 v[154:155], v213 offset:49664
    s_add_u32 m0, s43, 20480
    v_mfma_f32_16x16x32_bf16 v[80:83], v[160:163], a[240:243], v[80:83]
    ds_read_b64_tr_b16 v[156:157], v213 offset:57344
    v_mfma_f32_16x16x32_bf16 v[96:99], v[160:163], a[244:247], v[96:99]
    ds_read_b64_tr_b16 v[158:159], v213 offset:57856
    v_mfma_f32_16x16x32_bf16 v[88:91], v[164:167], a[240:243], v[88:91]
    ds_read_b64_tr_b16 v[160:161], v212 offset:53248
    buffer_load_dwordx4 v226, s[36:39], s10 offen offset:0 lds
    v_mfma_f32_16x16x32_bf16 v[104:107], v[164:167], a[244:247], v[104:107]
    s_waitcnt lgkmcnt(9)
    ds_read_b64_tr_b16 v[162:163], v212 offset:53760
    v_mfma_f32_16x16x32_bf16 v[84:87], v[168:171], a[240:243], v[84:87]
    ds_read_b64_tr_b16 v[164:165], v212 offset:61440
    v_mfma_f32_16x16x32_bf16 v[100:103], v[168:171], a[244:247], v[100:103]
    ds_read_b64_tr_b16 v[166:167], v212 offset:61952
    v_mfma_f32_16x16x32_bf16 v[92:95], v[172:175], a[240:243], v[92:95]
    ds_read_b64_tr_b16 v[168:169], v213 offset:53248
    buffer_load_dwordx4 v227, s[36:39], s10 offen offset:1024 lds
    v_mfma_f32_16x16x32_bf16 v[108:111], v[172:175], a[244:247], v[108:111]
    s_add_u32 m0, s43, 22528
    ds_read_b64_tr_b16 v[170:171], v213 offset:53760
    buffer_load_dwordx4 v228, s[36:39], s10 offen offset:0 lds
    buffer_load_dwordx4 v229, s[36:39], s10 offen offset:1024 lds
    s_waitcnt lgkmcnt(0)
    s_bfe_u32 s23, s54, 0x80000
    s_cmp_lg_u32 s23, 7
    s_cbranch_scc0 POLL0_X
    s_mov_b32 s51, 0
POLL0:
    s_load_dword s54, s[52:53], 0x0 glc
    s_add_u32 s51, s51, 1
    s_waitcnt lgkmcnt(0)
    s_cmp_gt_u32 s51, 200000
    s_cbranch_scc1 POLL0_X
    s_bfe_u32 s23, s54, 0x80000
    s_cmp_lg_u32 s23, 7
    s_cbranch_scc1 POLL0
POLL0_X:
    s_nop 3
    v_pk_mul_f32 v[176:177], v[80:81], v[80:81]
    v_pk_mul_f32 v[178:179], v[82:83], v[82:83]
    v_pk_mul_f32 v[180:181], v[84:85], v[84:85]
    v_pk_mul_f32 v[182:183], v[86:87], v[86:87]
    v_pk_fma_f32 v[176:177], v[176:177], v[224:225], v[222:223]
    v_pk_fma_f32 v[178:179], v[178:179], v[224:225], v[222:223]
    v_pk_fma_f32 v[180:181], v[180:181], v[224:225], v[222:223]
    v_pk_fma_f32 v[182:183], v[182:183], v[224:225], v[222:223]
    v_pk_mul_f32 v[176:177], v[176:177], v[80:81]
    v_pk_mul_f32 v[178:179], v[178:179], v[82:83]
    v_pk_mul_f32 v[180:181], v[180:181], v[84:85]
    v_pk_mul_f32 v[182:183], v[182:183], v[86:87]
    v_exp_f32 v176, v176
    v_exp_f32 v177, v177
    v_exp_f32 v178, v178
    v_exp_f32 v179, v179
    v_exp_f32 v180, v180
    v_exp_f32 v181, v181
    v_exp_f32 v182, v182
    buffer_load_dwordx4 v[16:19], v242, s[32:35], s4 offen offset:0 sc1
    v_exp_f32 v183, v183
    v_pk_mul_f32 v[80:81], v[80:81], v[88:89]
    v_pk_mul_f32 v[82:83], v[82:83], v[90:91]
    v_pk_mul_f32 v[84:85], v[84:85], v[92:93]
    v_pk_mul_f32 v[86:87], v[86:87], v[94:95]
    v_pk_add_f32 v[176:177], v[176:177], 1.0 op_sel_hi:[1,0]
    v_pk_add_f32 v[178:179], v[178:179], 1.0 op_sel_hi:[1,0]
    v_pk_add_f32 v[180:181], v[180:181], 1.0 op_sel_hi:[1,0]
    v_pk_add_f32 v[182:183], v[182:183], 1.0 op_sel_hi:[1,0]
    v_rcp_f32 v176, v176
    v_rcp_f32 v177, v177
    v_rcp_f32 v178, v178
    v_rcp_f32 v179, v179
    v_rcp_f32 v180, v180
    v_rcp_f32 v181, v181
    v_rcp_f32 v182, v182
    buffer_load_dwordx4 v[20:23], v242, s[32:35], s4 offen offset:2048 sc1
    v_rcp_f32 v183, v183
    v_pk_mul_f32 v[80:81], v[80:81], v[176:177]
    v_pk_mul_f32 v[82:83], v[82:83], v[178:179]
    v_pk_mul_f32 v[84:85], v[84:85], v[180:181]
    v_pk_mul_f32 v[86:87], v[86:87], v[182:183]
    v_cvt_pk_bf16_f32 v88, v80, v81
    v_cvt_pk_bf16_f32 v89, v82, v83
    v_cvt_pk_bf16_f32 v90, v84, v85
    v_cvt_pk_bf16_f32 v91, v86, v87
    buffer_store_dwordx4 v[88:91], v221, s[32:35], s1 offen offset:0 sc1
    v_pk_mul_f32 v[184:185], v[96:97], v[96:97]
    v_pk_mul_f32 v[186:187], v[98:99], v[98:99]
    v_pk_mul_f32 v[188:189], v[100:101], v[100:101]
    v_pk_mul_f32 v[190:191], v[102:103], v[102:103]
    v_pk_fma_f32 v[184:185], v[184:185], v[224:225], v[222:223]
    v_pk_fma_f32 v[186:187], v[186:187], v[224:225], v[222:223]
    v_pk_fma_f32 v[188:189], v[188:189], v[224:225], v[222:223]
    v_pk_fma_f32 v[190:191], v[190:191], v[224:225], v[222:223]
    v_pk_mul_f32 v[184:185], v[184:185], v[96:97]
    v_pk_mul_f32 v[186:187], v[186:187], v[98:99]
    v_pk_mul_f32 v[188:189], v[188:189], v[100:101]
    v_pk_mul_f32 v[190:191], v[190:191], v[102:103]
    v_exp_f32 v184, v184
    v_exp_f32 v185, v185
    v_exp_f32 v186, v186
    v_exp_f32 v187, v187
    v_exp_f32 v188, v188
    v_exp_f32 v189, v189
    v_exp_f32 v190, v190
    buffer_load_dwordx4 v[24:27], v243, s[32:35], s4 offen offset:0 sc1
    v_exp_f32 v191, v191
    v_pk_mul_f32 v[96:97], v[96:97], v[104:105]
    v_pk_mul_f32 v[98:99], v[98:99], v[106:107]
    v_pk_mul_f32 v[100:101], v[100:101], v[108:109]
    v_pk_mul_f32 v[102:103], v[102:103], v[110:111]
    v_pk_add_f32 v[184:185], v[184:185], 1.0 op_sel_hi:[1,0]
    v_pk_add_f32 v[186:187], v[186:187], 1.0 op_sel_hi:[1,0]
    v_pk_add_f32 v[188:189], v[188:189], 1.0 op_sel_hi:[1,0]
    v_pk_add_f32 v[190:191], v[190:191], 1.0 op_sel_hi:[1,0]
    v_rcp_f32 v184, v184
    v_rcp_f32 v185, v185
    v_rcp_f32 v186, v186
    v_rcp_f32 v187, v187
    v_rcp_f32 v188, v188
    v_rcp_f32 v189, v189
    v_rcp_f32 v190, v190
    buffer_load_dwordx4 v[28:31], v243, s[32:35], s4 offen offset:2048 sc1
    v_rcp_f32 v191, v191
    v_pk_mul_f32 v[96:97], v[96:97], v[184:185]
    v_pk_mul_f32 v[98:99], v[98:99], v[186:187]
    v_pk_mul_f32 v[100:101], v[100:101], v[188:189]
    v_pk_mul_f32 v[102:103], v[102:103], v[190:191]
    v_cvt_pk_bf16_f32 v104, v96, v97
    v_cvt_pk_bf16_f32 v105, v98, v99
    v_cvt_pk_bf16_f32 v106, v100, v101
    v_cvt_pk_bf16_f32 v107, v102, v103
    buffer_store_dwordx4 v[104:107], v221, s[32:35], s1 offen offset:2048 sc1
    v_mfma_f32_16x16x32_bf16 v[112:115], v[144:147], a[232:235], v[112:115]
    ds_read_b64_tr_b16 v[172:173], v213 offset:61440
    v_mfma_f32_16x16x32_bf16 v[128:131], v[144:147], a[236:239], v[128:131]
    ds_read_b64_tr_b16 v[174:175], v213 offset:61952
    v_mfma_f32_16x16x32_bf16 v[120:123], v[148:151], a[232:235], v[120:123]
    ds_read_b64_tr_b16 a[152:153], v246 offset:4096
    buffer_load_dwordx4 v[32:35], v242, s[32:35], s5 offen offset:0 sc1
    v_mfma_f32_16x16x32_bf16 v[136:139], v[148:151], a[236:239], v[136:139]
    ds_read_b64_tr_b16 a[156:157], v247 offset:4096
    v_mfma_f32_16x16x32_bf16 v[116:119], v[152:155], a[232:235], v[116:119]
    s_waitcnt vmcnt(23)
    ds_read_b64_tr_b16 a[146:147], v244 offset:6144
    v_mfma_f32_16x16x32_bf16 v[132:135], v[152:155], a[236:239], v[132:135]
    ds_read_b64_tr_b16 a[150:151], v245 offset:6144
    v_mfma_f32_16x16x32_bf16 v[124:127], v[156:159], a[232:235], v[124:127]
    ds_read_b64_tr_b16 a[154:155], v246 offset:6144
    buffer_load_dwordx4 v[36:39], v242, s[32:35], s5 offen offset:2048 sc1
    v_mfma_f32_16x16x32_bf16 v[140:143], v[156:159], a[236:239], v[140:143]
    ds_read_b64_tr_b16 a[158:159], v247 offset:6144
    v_mfma_f32_16x16x32_bf16 v[112:115], v[160:163], a[248:251], v[112:115]
    s_waitcnt vmcnt(22)
    ds_read_b64_tr_b16 a[160:161], v244 offset:8192
    v_mfma_f32_16x16x32_bf16 v[128:131], v[160:163], a[252:255], v[128:131]
    ds_read_b64_tr_b16 a[164:165], v245 offset:8192
    v_mfma_f32_16x16x32_bf16 v[120:123], v[164:167], a[248:251], v[120:123]
    ds_read_b64_tr_b16 a[168:169], v246 offset:8192
    buffer_load_dwordx4 v[40:43], v243, s[32:35], s5 offen offset:0 sc1
    v_mfma_f32_16x16x32_bf16 v[136:139], v[164:167], a[252:255], v[136:139]
    ds_read_b64_tr_b16 a[172:173], v247 offset:8192
    v_mfma_f32_16x16x32_bf16 v[116:119], v[168:171], a[248:251], v[116:119]
    s_waitcnt vmcnt(21) lgkmcnt(10)
    ds_read_b64_tr_b16 a[162:163], v244 offset:10240
    v_mfma_f32_16x16x32_bf16 v[132:135], v[168:171], a[252:255], v[132:135]
    ds_read_b64_tr_b16 a[166:167], v245 offset:10240
    v_mfma_f32_16x16x32_bf16 v[124:127], v[172:175], a[248:251], v[124:127]
    ds_read_b64_tr_b16 a[170:171], v246 offset:10240
    buffer_load_dwordx4 v[44:47], v243, s[32:35], s5 offen offset:2048 sc1
    v_mfma_f32_16x16x32_bf16 v[140:143], v[172:175], a[252:255], v[140:143]
    ds_read_b64_tr_b16 a[174:175], v247 offset:10240
    buffer_load_dwordx4 v[48:51], v242, s[32:35], s6 offen offset:0 sc1
    buffer_load_dwordx4 v[52:55], v242, s[32:35], s6 offen offset:2048 sc1
    s_nop 3
    v_pk_mul_f32 v[176:177], v[112:113], v[112:113]
    v_pk_mul_f32 v[178:179], v[114:115], v[114:115]
    v_pk_mul_f32 v[180:181], v[116:117], v[116:117]
    v_pk_mul_f32 v[182:183], v[118:119], v[118:119]
    v_pk_fma_f32 v[176:177], v[176:177], v[224:225], v[222:223]
    v_pk_fma_f32 v[178:179], v[178:179], v[224:225], v[222:223]
    v_pk_fma_f32 v[180:181], v[180:181], v[224:225], v[222:223]
    v_pk_fma_f32 v[182:183], v[182:183], v[224:225], v[222:223]
    v_pk_mul_f32 v[176:177], v[176:177], v[112:113]
    v_pk_mul_f32 v[178:179], v[178:179], v[114:115]
    v_pk_mul_f32 v[180:181], v[180:181], v[116:117]
    v_pk_mul_f32 v[182:183], v[182:183], v[118:119]
    v_exp_f32 v176, v176
    v_exp_f32 v177, v177
    v_exp_f32 v178, v178
    v_exp_f32 v179, v179
    v_exp_f32 v180, v180
    v_exp_f32 v181, v181
    v_exp_f32 v182, v182
    v_exp_f32 v183, v183
    v_pk_mul_f32 v[112:113], v[112:113], v[120:121]
    v_pk_mul_f32 v[114:115], v[114:115], v[122:123]
    v_pk_mul_f32 v[116:117], v[116:117], v[124:125]
    v_pk_mul_f32 v[118:119], v[118:119], v[126:127]
    v_pk_add_f32 v[176:177], v[176:177], 1.0 op_sel_hi:[1,0]
    v_pk_add_f32 v[178:179], v[178:179], 1.0 op_sel_hi:[1,0]
    v_pk_add_f32 v[180:181], v[180:181], 1.0 op_sel_hi:[1,0]
    buffer_load_dwordx4 v[56:59], v243, s[32:35], s6 offen offset:0 sc1
    v_pk_add_f32 v[182:183], v[182:183], 1.0 op_sel_hi:[1,0]
    v_rcp_f32 v176, v176
    v_rcp_f32 v177, v177
    v_rcp_f32 v178, v178
    v_rcp_f32 v179, v179
    v_rcp_f32 v180, v180
    v_rcp_f32 v181, v181
    v_rcp_f32 v182, v182
    v_rcp_f32 v183, v183
    v_pk_mul_f32 v[112:113], v[112:113], v[176:177]
    v_pk_mul_f32 v[114:115], v[114:115], v[178:179]
    v_pk_mul_f32 v[116:117], v[116:117], v[180:181]
    v_pk_mul_f32 v[118:119], v[118:119], v[182:183]
    v_cvt_pk_bf16_f32 v120, v112, v113
    v_cvt_pk_bf16_f32 v121, v114, v115
    v_cvt_pk_bf16_f32 v122, v116, v117
    v_cvt_pk_bf16_f32 v123, v118, v119
    buffer_store_dwordx4 v[120:123], v221, s[32:35], s101 offen offset:0 sc1
    s_mov_b64 exec, 1
    s_waitcnt vmcnt(8)
    buffer_atomic_add v238, v240, s[32:35], s50 offen sc1
    s_mov_b64 exec, -1
    s_nop 0
    v_pk_mul_f32 v[184:185], v[128:129], v[128:129]
    v_pk_mul_f32 v[186:187], v[130:131], v[130:131]
    v_pk_mul_f32 v[188:189], v[132:133], v[132:133]
    v_pk_mul_f32 v[190:191], v[134:135], v[134:135]
    v_pk_fma_f32 v[184:185], v[184:185], v[224:225], v[222:223]
    v_pk_fma_f32 v[186:187], v[186:187], v[224:225], v[222:223]
    v_pk_fma_f32 v[188:189], v[188:189], v[224:225], v[222:223]
    v_pk_fma_f32 v[190:191], v[190:191], v[224:225], v[222:223]
    v_pk_mul_f32 v[184:185], v[184:185], v[128:129]
    v_pk_mul_f32 v[186:187], v[186:187], v[130:131]
    v_pk_mul_f32 v[188:189], v[188:189], v[132:133]
    v_pk_mul_f32 v[190:191], v[190:191], v[134:135]
    v_exp_f32 v184, v184
    v_exp_f32 v185, v185
    v_exp_f32 v186, v186
    v_exp_f32 v187, v187
    v_exp_f32 v188, v188
    v_exp_f32 v189, v189
    v_exp_f32 v190, v190
    v_exp_f32 v191, v191
    v_pk_mul_f32 v[128:129], v[128:129], v[136:137]
    v_pk_mul_f32 v[130:131], v[130:131], v[138:139]
    v_pk_mul_f32 v[132:133], v[132:133], v[140:141]
    v_pk_mul_f32 v[134:135], v[134:135], v[142:143]
    v_pk_add_f32 v[184:185], v[184:185], 1.0 op_sel_hi:[1,0]
    v_pk_add_f32 v[186:187], v[186:187], 1.0 op_sel_hi:[1,0]
    v_pk_add_f32 v[188:189], v[188:189], 1.0 op_sel_hi:[1,0]
    buffer_load_dwordx4 v[60:63], v243, s[32:35], s6 offen offset:2048 sc1
    v_pk_add_f32 v[190:191], v[190:191], 1.0 op_sel_hi:[1,0]
    v_rcp_f32 v184, v184
    v_rcp_f32 v185, v185
    v_rcp_f32 v186, v186
    v_rcp_f32 v187, v187
    v_rcp_f32 v188, v188
    v_rcp_f32 v189, v189
    v_rcp_f32 v190, v190
    v_rcp_f32 v191, v191
    v_pk_mul_f32 v[128:129], v[128:129], v[184:185]
    v_pk_mul_f32 v[130:131], v[130:131], v[186:187]
    v_pk_mul_f32 v[132:133], v[132:133], v[188:189]
    v_pk_mul_f32 v[134:135], v[134:135], v[190:191]
    v_cvt_pk_bf16_f32 v136, v128, v129
    v_cvt_pk_bf16_f32 v137, v130, v131
    v_cvt_pk_bf16_f32 v138, v132, v133
    v_cvt_pk_bf16_f32 v139, v134, v135
    buffer_store_dwordx4 v[136:139], v221, s[32:35], s101 offen offset:2048 sc1
    buffer_load_dwordx4 v[64:67], v242, s[32:35], s7 offen offset:0 sc1
    buffer_load_dwordx4 v[68:71], v242, s[32:35], s7 offen offset:2048 sc1
JOIN:
    s_mov_b32 s24, s12
    s_and_b32 s25, s13, 0xffff
    s_mov_b32 s26, 2097152
    s_mov_b32 s27, 0x20000
    v_mfma_f32_16x16x32_bf16 v[80:83], v[16:19], a[0:3], 0
    ds_read_b64_tr_b16 a[176:177], v244 offset:12288
    v_mfma_f32_16x16x32_bf16 v[84:87], v[16:19], a[4:7], 0
    ds_read_b64_tr_b16 a[180:181], v245 offset:12288
    buffer_load_dwordx4 v[72:75], v243, s[32:35], s7 offen offset:0 sc1
    v_mfma_f32_16x16x32_bf16 v[88:91], v[16:19], a[8:11], 0
    ds_read_b64_tr_b16 a[184:185], v246 offset:12288
    v_mfma_f32_16x16x32_bf16 v[92:95], v[16:19], a[12:15], 0
    ds_read_b64_tr_b16 a[188:189], v247 offset:12288
    v_mfma_f32_16x16x32_bf16 v[96:99], v[20:23], a[0:3], 0
    ds_read_b64_tr_b16 a[178:179], v244 offset:14336
    v_mfma_f32_16x16x32_bf16 v[100:103], v[20:23], a[4:7], 0
    ds_read_b64_tr_b16 a[182:183], v245 offset:14336
    buffer_load_dwordx4 v[76:79], v243, s[32:35], s7 offen offset:2048 sc1
    v_mfma_f32_16x16x32_bf16 v[104:107], v[20:23], a[8:11], 0
    ds_read_b64_tr_b16 a[186:187], v246 offset:14336
    v_mfma_f32_16x16x32_bf16 v[108:111], v[20:23], a[12:15], 0
    ds_read_b64_tr_b16 a[190:191], v247 offset:14336
    v_mfma_f32_16x16x32_bf16 v[112:115], v[24:27], a[0:3], 0
    ds_read_b64_tr_b16 a[192:193], v244 offset:16384
    v_mfma_f32_16x16x32_bf16 v[116:119], v[24:27], a[4:7], 0
    ds_read_b64_tr_b16 a[196:197], v245 offset:16384
    buffer_load_dwordx4 v[192:195], v242, s[32:35], s8 offen offset:0 sc1
    v_mfma_f32_16x16x32_bf16 v[120:123], v[24:27], a[8:11], 0
    ds_read_b64_tr_b16 a[200:201], v246 offset:16384
    v_mfma_f32_16x16x32_bf16 v[124:127], v[24:27], a[12:15], 0
    ds_read_b64_tr_b16 a[204:205], v247 offset:16384
    v_mfma_f32_16x16x32_bf16 v[128:131], v[28:31], a[0:3], 0
    ds_read_b64_tr_b16 a[194:195], v244 offset:18432
    v_mfma_f32_16x16x32_bf16 v[132:135], v[28:31], a[4:7], 0
    s_branch SEG3
.p2align 12
PAD3:
    s_branch PADRET3
    s_nop 0
SEG3:
    ds_read_b64_tr_b16 a[198:199], v245 offset:18432
    buffer_load_dwordx4 v[196:199], v242, s[32:35], s8 offen offset:2048 sc1
    v_mfma_f32_16x16x32_bf16 v[136:139], v[28:31], a[8:11], 0
    ds_read_b64_tr_b16 a[202:203], v246 offset:18432
    v_mfma_f32_16x16x32_bf16 v[140:143], v[28:31], a[12:15], 0
    ds_read_b64_tr_b16 a[206:207], v247 offset:18432
    s_waitcnt vmcnt(16)
    v_mfma_f32_16x16x32_bf16 v[80:83], v[32:35], a[16:19], v[80:83]
    ds_read_b64_tr_b16 a[208:209], v244 offset:20480
    v_mfma_f32_16x16x32_bf16 v[84:87], v[32:35], a[20:23], v[84:87]
    ds_read_b64_tr_b16 a[212:213], v245 offset:20480
    buffer_load_dwordx4 v[200:203], v243, s[32:35], s8 offen offset:0 sc1
    v_mfma_f32_16x16x32_bf16 v[88:91], v[32:35], a[24:27], v[88:91]
    ds_read_b64_tr_b16 a[216:217], v246 offset:20480
    v_mfma_f32_16x16x32_bf16 v[92:95], v[32:35], a[28:31], v[92:95]
    ds_read_b64_tr_b16 a[220:221], v247 offset:20480
    s_waitcnt vmcnt(16)
    v_mfma_f32_16x16x32_bf16 v[96:99], v[36:39], a[16:19], v[96:99]
    ds_read_b64_tr_b16 a[210:211], v244 offset:22528
    v_mfma_f32_16x16x32_bf16 v[100:103], v[36:39], a[20:23], v[100:103]
    ds_read_b64_tr_b16 a[214:215], v245 offset:22528
    buffer_load_dwordx4 v[204:207], v243, s[32:35], s8 offen offset:2048 sc1
    v_mfma_f32_16x16x32_bf16 v[104:107], v[36:39], a[24:27], v[104:107]
    ds_read_b64_tr_b16 a[218:219], v246 offset:22528
    v_mfma_f32_16x16x32_bf16 v[108:111], v[36:39], a[28:31], v[108:111]
    ds_read_b64_tr_b16 a[222:223], v247 offset:22528
    s_waitcnt vmcnt(16)
    v_mfma_f32_16x16x32_bf16 v[112:115], v[40:43], a[16:19], v[112:115]
    v_mfma_f32_16x16x32_bf16 v[116:119], v[40:43], a[20:23], v[116:119]
    buffer_load_dwordx4 v[144:147], v242, s[32:35], s9 offen offset:0 sc1
    v_mfma_f32_16x16x32_bf16 v[120:123], v[40:43], a[24:27], v[120:123]
    v_mfma_f32_16x16x32_bf16 v[124:127], v[40:43], a[28:31], v[124:127]
    s_waitcnt vmcnt(16)
    v_mfma_f32_16x16x32_bf16 v[128:131], v[44:47], a[16:19], v[128:131]
    v_mfma_f32_16x16x32_bf16 v[132:135], v[44:47], a[20:23], v[132:135]
    buffer_load_dwordx4 v[148:151], v242, s[32:35], s9 offen offset:2048 sc1
    v_mfma_f32_16x16x32_bf16 v[136:139], v[44:47], a[24:27], v[136:139]
    v_mfma_f32_16x16x32_bf16 v[140:143], v[44:47], a[28:31], v[140:143]
    s_waitcnt vmcnt(16)
    v_mfma_f32_16x16x32_bf16 v[80:83], v[48:51], a[32:35], v[80:83]
    v_mfma_f32_16x16x32_bf16 v[84:87], v[48:51], a[36:39], v[84:87]
    buffer_load_dwordx4 v[152:155], v243, s[32:35], s9 offen offset:0 sc1
    v_mfma_f32_16x16x32_bf16 v[88:91], v[48:51], a[40:43], v[88:91]
    v_mfma_f32_16x16x32_bf16 v[92:95], v[48:51], a[44:47], v[92:95]
    s_waitcnt vmcnt(16)
    v_mfma_f32_16x16x32_bf16 v[96:99], v[52:55], a[32:35], v[96:99]
    v_mfma_f32_16x16x32_bf16 v[100:103], v[52:55], a[36:39], v[100:103]
    buffer_load_dwordx4 v[156:159], v243, s[32:35], s9 offen offset:2048 sc1
    v_mfma_f32_16x16x32_bf16 v[104:107], v[52:55], a[40:43], v[104:107]
    v_mfma_f32_16x16x32_bf16 v[108:111], v[52:55], a[44:47], v[108:111]
    s_load_dword s54, s[52:53], 0x0 glc
    s_waitcnt vmcnt(16)
    v_mfma_f32_16x16x32_bf16 v[112:115], v[56:59], a[32:35], v[112:115]
    v_mfma_f32_16x16x32_bf16 v[116:119], v[56:59], a[36:39], v[116:119]
    buffer_load_dwordx4 v[160:163], v242, s[32:35], s10 offen offset:0 sc1
    v_mfma_f32_16x16x32_bf16 v[120:123], v[56:59], a[40:43], v[120:123]
    v_mfma_f32_16x16x32_bf16 v[124:127], v[56:59], a[44:47], v[124:127]
    s_waitcnt vmcnt(14)
    v_mfma_f32_16x16x32_bf16 v[128:131], v[60:63], a[32:35], v[128:131]
    v_mfma_f32_16x16x32_bf16 v[132:135], v[60:63], a[36:39], v[132:135]
    buffer_load_dwordx4 v[164:167], v242, s[32:35], s10 offen offset:2048 sc1
    v_mfma_f32_16x16x32_bf16 v[136:139], v[60:63], a[40:43], v[136:139]
    v_mfma_f32_16x16x32_bf16 v[140:143], v[60:63], a[44:47], v[140:143]
    s_cmp_eq_u32 s11, 1
    s_cbranch_scc1 NOSIG3
    s_mov_b64 exec, 1
    s_waitcnt vmcnt(14)
    buffer_atomic_add v239, v240, s[32:35], s50 offen sc1
    s_mov_b64 exec, -1
NOSIG3:
    s_waitcnt vmcnt(13)
    v_mfma_f32_16x16x32_bf16 v[80:83], v[64:67], a[48:51], v[80:83]
    v_mfma_f32_16x16x32_bf16 v[84:87], v[64:67], a[52:55], v[84:87]
    v_add_u32 v242, 0x10000, v242
    buffer_load_dwordx4 v[168:171], v243, s[32:35], s10 offen offset:0 sc1
    v_mfma_f32_16x16x32_bf16 v[88:91], v[64:67], a[56:59], v[88:91]
    v_mfma_f32_16x16x32_bf16 v[92:95], v[64:67], a[60:63], v[92:95]
    s_waitcnt vmcnt(13)
    v_mfma_f32_16x16x32_bf16 v[96:99], v[68:71], a[48:51], v[96:99]
    v_mfma_f32_16x16x32_bf16 v[100:103], v[68:71], a[52:55], v[100:103]
    buffer_load_dwordx4 v[172:175], v243, s[32:35], s10 offen offset:2048 sc1
    v_mfma_f32_16x16x32_bf16 v[104:107], v[68:71], a[56:59], v[104:107]
    v_mfma_f32_16x16x32_bf16 v[108:111], v[68:71], a[60:63], v[108:111]
    s_waitcnt vmcnt(13)
    v_mfma_f32_16x16x32_bf16 v[112:115], v[72:75], a[48:51], v[112:115]
    v_mfma_f32_16x16x32_bf16 v[116:119], v[72:75], a[52:55], v[116:119]
    v_add_u32 v243, 0x10000, v243
    v_mfma_f32_16x16x32_bf16 v[120:123], v[72:75], a[56:59], v[120:123]
    v_mfma_f32_16x16x32_bf16 v[124:127], v[72:75], a[60:63], v[124:127]
    s_waitcnt vmcnt(12)
    v_mfma_f32_16x16x32_bf16 v[128:131], v[76:79], a[48:51], v[128:131]
    v_mfma_f32_16x16x32_bf16 v[132:135], v[76:79], a[52:55], v[132:135]
    v_mfma_f32_16x16x32_bf16 v[136:139], v[76:79], a[56:59], v[136:139]
    v_mfma_f32_16x16x32_bf16 v[140:143], v[76:79], a[60:63], v[140:143]
    s_waitcnt vmcnt(11)
    v_mfma_f32_16x16x32_bf16 v[80:83], v[192:195], a[64:67], v[80:83]
    v_mfma_f32_16x16x32_bf16 v[84:87], v[192:195], a[68:71], v[84:87]
    v_mfma_f32_16x16x32_bf16 v[88:91], v[192:195], a[72:75], v[88:91]
    v_mfma_f32_16x16x32_bf16 v[92:95], v[192:195], a[76:79], v[92:95]
    s_waitcnt vmcnt(10)
    v_mfma_f32_16x16x32_bf16 v[96:99], v[196:199], a[64:67], v[96:99]
    v_mfma_f32_16x16x32_bf16 v[100:103], v[196:199], a[68:71], v[100:103]
    v_mfma_f32_16x16x32_bf16 v[104:107], v[196:199], a[72:75], v[104:107]
    v_mfma_f32_16x16x32_bf16 v[108:111], v[196:199], a[76:79], v[108:111]
    s_waitcnt vmcnt(9)
    v_mfma_f32_16x16x32_bf16 v[112:115], v[200:203], a[64:67], v[112:115]
    v_mfma_f32_16x16x32_bf16 v[116:119], v[200:203], a[68:71], v[116:119]
    s_waitcnt lgkmcnt(0)
    s_bfe_u32 s23, s54, 0x80010
    s_cmp_lg_u32 s23, 7
    s_cbranch_scc0 POLL2_X
    s_mov_b32 s51, 0
POLL2:
    s_load_dword s54, s[52:53], 0x0 glc
    s_add_u32 s51, s51, 1
    s_waitcnt lgkmcnt(0)
    s_cmp_gt_u32 s51, 200000
    s_cbranch_scc1 POLL2_X
    s_bfe_u32 s23, s54, 0x80010
    s_cmp_lg_u32 s23, 7
    s_cbranch_scc1 POLL2
POLL2_X:
    buffer_load_dwordx4 v[176:179], v242, s[32:35], s4 offen offset:0 sc1
    v_mfma_f32_16x16x32_bf16 v[120:123], v[200:203], a[72:75], v[120:123]
    v_mfma_f32_16x16x32_bf16 v[124:127], v[200:203], a[76:79], v[124:127]
    s_waitcnt vmcnt(9)
    v_mfma_f32_16x16x32_bf16 v[128:131], v[204:207], a[64:67], v[128:131]
    v_mfma_f32_16x16x32_bf16 v[132:135], v[204:207], a[68:71], v[132:135]
    buffer_load_dwordx4 v[180:183], v242, s[32:35], s5 offen offset:0 sc1
    v_mfma_f32_16x16x32_bf16 v[136:139], v[204:207], a[72:75], v[136:139]
    v_mfma_f32_16x16x32_bf16 v[140:143], v[204:207], a[76:79], v[140:143]
    s_waitcnt vmcnt(9)
    v_mfma_f32_16x16x32_bf16 v[80:83], v[144:147], a[80:83], v[80:83]
    v_mfma_f32_16x16x32_bf16 v[84:87], v[144:147], a[84:87], v[84:87]
    buffer_load_dwordx4 v[184:187], v242, s[32:35], s6 offen offset:0 sc1
    v_mfma_f32_16x16x32_bf16 v[88:91], v[144:147], a[88:91], v[88:91]
    v_mfma_f32_16x16x32_bf16 v[92:95], v[144:147], a[92:95], v[92:95]
    s_waitcnt vmcnt(9)
    v_mfma_f32_16x16x32_bf16 v[96:99], v[148:151], a[80:83], v[96:99]
    v_mfma_f32_16x16x32_bf16 v[100:103], v[148:151], a[84:87], v[100:103]
    buffer_load_dwordx4 v[188:191], v242, s[32:35], s7 offen offset:0 sc1
    v_mfma_f32_16x16x32_bf16 v[104:107], v[148:151], a[88:91], v[104:107]
    v_mfma_f32_16x16x32_bf16 v[108:111], v[148:151], a[92:95], v[108:111]
    s_waitcnt vmcnt(9)
    v_mfma_f32_16x16x32_bf16 v[112:115], v[152:155], a[80:83], v[112:115]
    v_mfma_f32_16x16x32_bf16 v[116:119], v[152:155], a[84:87], v[116:119]
    buffer_load_dwordx4 v[16:19], v242, s[32:35], s8 offen offset:0 sc1
    v_mfma_f32_16x16x32_bf16 v[120:123], v[152:155], a[88:91], v[120:123]
    v_mfma_f32_16x16x32_bf16 v[124:127], v[152:155], a[92:95], v[124:127]
    s_waitcnt vmcnt(9)
    v_mfma_f32_16x16x32_bf16 v[128:131], v[156:159], a[80:83], v[128:131]
    v_mfma_f32_16x16x32_bf16 v[132:135], v[156:159], a[84:87], v[132:135]
    buffer_load_dwordx4 v[20:23], v242, s[32:35], s9 offen offset:0 sc1
    v_mfma_f32_16x16x32_bf16 v[136:139], v[156:159], a[88:91], v[136:139]
    v_mfma_f32_16x16x32_bf16 v[140:143], v[156:159], a[92:95], v[140:143]
    s_load_dword s54, s[52:53], 0x0 glc
    s_waitcnt vmcnt(9)
    v_mfma_f32_16x16x32_bf16 v[80:83], v[160:163], a[96:99], v[80:83]
    v_mfma_f32_16x16x32_bf16 v[84:87], v[160:163], a[100:103], v[84:87]
    buffer_load_dwordx4 v[24:27], v242, s[32:35], s10 offen offset:0 sc1
    v_mfma_f32_16x16x32_bf16 v[88:91], v[160:163], a[104:107], v[88:91]
    v_mfma_f32_16x16x32_bf16 v[92:95], v[160:163], a[108:111], v[92:95]
    s_waitcnt vmcnt(9)
    v_mfma_f32_16x16x32_bf16 v[96:99], v[164:167], a[96:99], v[96:99]
    v_mfma_f32_16x16x32_bf16 v[100:103], v[164:167], a[100:103], v[100:103]
    buffer_load_dwordx4 v[28:31], v242, s[32:35], s4 offen offset:2048 sc1
    v_mfma_f32_16x16x32_bf16 v[104:107], v[164:167], a[104:107], v[104:107]
    v_mfma_f32_16x16x32_bf16 v[108:111], v[164:167], a[108:111], v[108:111]
    s_waitcnt vmcnt(9)
    v_mfma_f32_16x16x32_bf16 v[112:115], v[168:171], a[96:99], v[112:115]
    v_mfma_f32_16x16x32_bf16 v[116:119], v[168:171], a[100:103], v[116:119]
    buffer_load_dwordx4 v[32:35], v242, s[32:35], s5 offen offset:2048 sc1
    v_mfma_f32_16x16x32_bf16 v[120:123], v[168:171], a[104:107], v[120:123]
    v_mfma_f32_16x16x32_bf16 v[124:127], v[168:171], a[108:111], v[124:127]
    s_waitcnt vmcnt(9)
    v_mfma_f32_16x16x32_bf16 v[128:131], v[172:175], a[96:99], v[128:131]
    v_mfma_f32_16x16x32_bf16 v[132:135], v[172:175], a[100:103], v[132:135]
    buffer_load_dwordx4 v[36:39], v242, s[32:35], s6 offen offset:2048 sc1
    v_mfma_f32_16x16x32_bf16 v[136:139], v[172:175], a[104:107], v[136:139]
    v_mfma_f32_16x16x32_bf16 v[140:143], v[172:175], a[108:111], v[140:143]
    s_waitcnt vmcnt(9)
    v_mfma_f32_16x16x32_bf16 v[80:83], v[176:179], a[112:115], v[80:83]
    v_mfma_f32_16x16x32_bf16 v[84:87], v[176:179], a[116:119], v[84:87]
    buffer_load_dwordx4 v[40:43], v242, s[32:35], s7 offen offset:2048 sc1
    v_mfma_f32_16x16x32_bf16 v[88:91], v[176:179], a[120:123], v[88:91]
    v_mfma_f32_16x16x32_bf16 v[92:95], v[176:179], a[124:127], v[92:95]
    s_waitcnt vmcnt(9)
    v_mfma_f32_16x16x32_bf16 v[80:83], v[180:183], a[128:131], v[80:83]
    v_mfma_f32_16x16x32_bf16 v[84:87], v[180:183], a[132:135], v[84:87]
    buffer_load_dwordx4 v[44:47], v242, s[32:35], s8 offen offset:2048 sc1
    v_mfma_f32_16x16x32_bf16 v[88:91], v[180:183], a[136:139], v[88:91]
    v_mfma_f32_16x16x32_bf16 v[92:95], v[180:183], a[140:143], v[92:95]
    s_waitcnt vmcnt(9)
    v_mfma_f32_16x16x32_bf16 v[80:83], v[184:187], a[144:147], v[80:83]
    v_mfma_f32_16x16x32_bf16 v[84:87], v[184:187], a[148:151], v[84:87]
    buffer_load_dwordx4 v[48:51], v242, s[32:35], s9 offen offset:2048 sc1
    v_mfma_f32_16x16x32_bf16 v[88:91], v[184:187], a[152:155], v[88:91]
    v_mfma_f32_16x16x32_bf16 v[92:95], v[184:187], a[156:159], v[92:95]
    s_waitcnt vmcnt(9)
    v_mfma_f32_16x16x32_bf16 v[80:83], v[188:191], a[160:163], v[80:83]
    v_mfma_f32_16x16x32_bf16 v[84:87], v[188:191], a[164:167], v[84:87]
    buffer_load_dwordx4 v[52:55], v242, s[32:35], s10 offen offset:2048 sc1
    v_mfma_f32_16x16x32_bf16 v[88:91], v[188:191], a[168:171], v[88:91]
    v_mfma_f32_16x16x32_bf16 v[92:95], v[188:191], a[172:175], v[92:95]
    s_waitcnt vmcnt(9)
    v_mfma_f32_16x16x32_bf16 v[80:83], v[16:19], a[176:179], v[80:83]
    v_mfma_f32_16x16x32_bf16 v[84:87], v[16:19], a[180:183], v[84:87]
    s_waitcnt lgkmcnt(0)
    s_bfe_u32 s23, s54, 0x80018
    s_cmp_lg_u32 s23, 7
    s_cbranch_scc0 POLL3_X
    s_mov_b32 s51, 0
POLL3:
    s_load_dword s54, s[52:53], 0x0 glc
    s_add_u32 s51, s51, 1
    s_waitcnt lgkmcnt(0)
    s_cmp_gt_u32 s51, 200000
    s_cbranch_scc1 POLL3_X
    s_bfe_u32 s23, s54, 0x80018
    s_cmp_lg_u32 s23, 7
    s_cbranch_scc1 POLL3
POLL3_X:
    buffer_load_dwordx4 v[56:59], v243, s[32:35], s4 offen offset:0 sc1
    v_mfma_f32_16x16x32_bf16 v[88:91], v[16:19], a[184:187], v[88:91]
    v_mfma_f32_16x16x32_bf16 v[92:95], v[16:19], a[188:191], v[92:95]
    s_waitcnt vmcnt(9)
    v_mfma_f32_16x16x32_bf16 v[80:83], v[20:23], a[192:195], v[80:83]
    v_mfma_f32_16x16x32_bf16 v[84:87], v[20:23], a[196:199], v[84:87]
    buffer_load_dwordx4 v[60:63], v243, s[32:35], s5 offen offset:0 sc1
    v_mfma_f32_16x16x32_bf16 v[88:91], v[20:23], a[200:203], v[88:91]
    v_mfma_f32_16x16x32_bf16 v[92:95], v[20:23], a[204:207], v[92:95]
    s_waitcnt vmcnt(9)
    v_mfma_f32_16x16x32_bf16 v[80:83], v[24:27], a[208:211], v[80:83]
    v_mfma_f32_16x16x32_bf16 v[84:87], v[24:27], a[212:215], v[84:87]
    buffer_load_dwordx4 v[64:67], v243, s[32:35], s6 offen offset:0 sc1
    v_mfma_f32_16x16x32_bf16 v[88:91], v[24:27], a[216:219], v[88:91]
    v_mfma_f32_16x16x32_bf16 v[92:95], v[24:27], a[220:223], v[92:95]
    s_waitcnt vmcnt(9)
    v_mfma_f32_16x16x32_bf16 v[96:99], v[28:31], a[112:115], v[96:99]
    v_mfma_f32_16x16x32_bf16 v[100:103], v[28:31], a[116:119], v[100:103]
    buffer_load_dwordx4 v[68:71], v243, s[32:35], s7 offen offset:0 sc1
    v_mfma_f32_16x16x32_bf16 v[104:107], v[28:31], a[120:123], v[104:107]
    v_mfma_f32_16x16x32_bf16 v[108:111], v[28:31], a[124:127], v[108:111]
    s_waitcnt vmcnt(9)
    v_mfma_f32_16x16x32_bf16 v[96:99], v[32:35], a[128:131], v[96:99]
    s_mul_i32 m0, s18, 24576
    v_mfma_f32_16x16x32_bf16 v[100:103], v[32:35], a[132:135], v[100:103]
    buffer_load_dwordx4 v[72:75], v243, s[32:35], s8 offen offset:0 sc1
    v_mfma_f32_16x16x32_bf16 v[104:107], v[32:35], a[136:139], v[104:107]
    ds_write_addtid_b32 v80 offset:0
    v_mfma_f32_16x16x32_bf16 v[108:111], v[32:35], a[140:143], v[108:111]
    ds_write_addtid_b32 v81 offset:320
    s_waitcnt vmcnt(9)
    v_mfma_f32_16x16x32_bf16 v[96:99], v[36:39], a[144:147], v[96:99]
    ds_write_addtid_b32 v82 offset:640
    v_mfma_f32_16x16x32_bf16 v[100:103], v[36:39], a[148:151], v[100:103]
    ds_write_addtid_b32 v83 offset:960
    buffer_load_dwordx4 v[76:79], v243, s[32:35], s9 offen offset:0 sc1
    v_mfma_f32_16x16x32_bf16 v[104:107], v[36:39], a[152:155], v[104:107]
    ds_write_addtid_b32 v84 offset:1296
    v_mfma_f32_16x16x32_bf16 v[108:111], v[36:39], a[156:159], v[108:111]
    ds_write_addtid_b32 v85 offset:1616
    s_waitcnt vmcnt(9)
    v_mfma_f32_16x16x32_bf16 v[96:99], v[40:43], a[160:163], v[96:99]
    ds_write_addtid_b32 v86 offset:1936
    v_mfma_f32_16x16x32_bf16 v[100:103], v[40:43], a[164:167], v[100:103]
    ds_write_addtid_b32 v87 offset:2256
    buffer_load_dwordx4 v[192:195], v243, s[32:35], s10 offen offset:0 sc1
    v_mfma_f32_16x16x32_bf16 v[104:107], v[40:43], a[168:171], v[104:107]
    ds_write_addtid_b32 v88 offset:2560
    v_mfma_f32_16x16x32_bf16 v[108:111], v[40:43], a[172:175], v[108:111]
    ds_write_addtid_b32 v89 offset:2880
    s_waitcnt vmcnt(9)
    v_mfma_f32_16x16x32_bf16 v[96:99], v[44:47], a[176:179], v[96:99]
    ds_write_addtid_b32 v90 offset:3200
    v_mfma_f32_16x16x32_bf16 v[100:103], v[44:47], a[180:183], v[100:103]
    ds_write_addtid_b32 v91 offset:3520
    buffer_load_dwordx4 v[196:199], v243, s[32:35], s4 offen offset:2048 sc1
    v_mfma_f32_16x16x32_bf16 v[104:107], v[44:47], a[184:187], v[104:107]
    ds_write_addtid_b32 v92 offset:3856
    v_mfma_f32_16x16x32_bf16 v[108:111], v[44:47], a[188:191], v[108:111]
    ds_write_addtid_b32 v93 offset:4176
    s_waitcnt vmcnt(9)
    v_mfma_f32_16x16x32_bf16 v[96:99], v[48:51], a[192:195], v[96:99]
    ds_write_addtid_b32 v94 offset:4496
    v_mfma_f32_16x16x32_bf16 v[100:103], v[48:51], a[196:199], v[100:103]
    ds_write_addtid_b32 v95 offset:4816
    buffer_load_dwordx4 v[200:203], v243, s[32:35], s5 offen offset:2048 sc1
    v_mfma_f32_16x16x32_bf16 v[104:107], v[48:51], a[200:203], v[104:107]
    v_mfma_f32_16x16x32_bf16 v[108:111], v[48:51], a[204:207], v[108:111]
    s_waitcnt vmcnt(9)
    v_mfma_f32_16x16x32_bf16 v[96:99], v[52:55], a[208:211], v[96:99]
    v_mfma_f32_16x16x32_bf16 v[100:103], v[52:55], a[212:215], v[100:103]
    buffer_load_dwordx4 v[204:207], v243, s[32:35], s6 offen offset:2048 sc1
    v_mfma_f32_16x16x32_bf16 v[104:107], v[52:55], a[216:219], v[104:107]
    v_mfma_f32_16x16x32_bf16 v[108:111], v[52:55], a[220:223], v[108:111]
    s_waitcnt vmcnt(9)
    v_mfma_f32_16x16x32_bf16 v[112:115], v[56:59], a[112:115], v[112:115]
    v_mfma_f32_16x16x32_bf16 v[116:119], v[56:59], a[116:119], v[116:119]
    buffer_load_dwordx4 v[144:147], v243, s[32:35], s7 offen offset:2048 sc1
    v_mfma_f32_16x16x32_bf16 v[120:123], v[56:59], a[120:123], v[120:123]
    v_mfma_f32_16x16x32_bf16 v[124:127], v[56:59], a[124:127], v[124:127]
    s_waitcnt vmcnt(9)
    v_mfma_f32_16x16x32_bf16 v[112:115], v[60:63], a[128:131], v[112:115]
    ds_write_addtid_b32 v96 offset:5120
    v_mfma_f32_16x16x32_bf16 v[116:119], v[60:63], a[132:135], v[116:119]
    ds_write_addtid_b32 v97 offset:5440
    buffer_load_dwordx4 v[148:151], v243, s[32:35], s8 offen offset:2048 sc1
    v_mfma_f32_16x16x32_bf16 v[120:123], v[60:63], a[136:139], v[120:123]
    ds_write_addtid_b32 v98 offset:5760
    v_mfma_f32_16x16x32_bf16 v[124:127], v[60:63], a[140:143], v[124:127]
    ds_write_addtid_b32 v99 offset:6080
    s_waitcnt vmcnt(9)
    v_mfma_f32_16x16x32_bf16 v[112:115], v[64:67], a[144:147], v[112:115]
    ds_write_addtid_b32 v100 offset:6416
    v_mfma_f32_16x16x32_bf16 v[116:119], v[64:67], a[148:151], v[116:119]
    ds_write_addtid_b32 v101 offset:6736
    buffer_load_dwordx4 v[152:155], v243, s[32:35], s9 offen offset:2048 sc1
    v_mfma_f32_16x16x32_bf16 v[120:123], v[64:67], a[152:155], v[120:123]
    ds_write_addtid_b32 v102 offset:7056
    v_mfma_f32_16x16x32_bf16 v[124:127], v[64:67], a[156:159], v[124:127]
    ds_write_addtid_b32 v103 offset:7376
    s_waitcnt vmcnt(9)
    v_mfma_f32_16x16x32_bf16 v[112:115], v[68:71], a[160:163], v[112:115]
    ds_write_addtid_b32 v104 offset:7680
    v_mfma_f32_16x16x32_bf16 v[116:119], v[68:71], a[164:167], v[116:119]
    ds_write_addtid_b32 v105 offset:8000
    buffer_load_dwordx4 v[156:159], v243, s[32:35], s10 offen offset:2048 sc1
    v_mfma_f32_16x16x32_bf16 v[120:123], v[68:71], a[168:171], v[120:123]
    ds_write_addtid_b32 v106 offset:8320
    v_mfma_f32_16x16x32_bf16 v[124:127], v[68:71], a[172:175], v[124:127]
    ds_write_addtid_b32 v107 offset:8640
    s_waitcnt vmcnt(9)
    v_mfma_f32_16x16x32_bf16 v[112:115], v[72:75], a[176:179], v[112:115]
    ds_write_addtid_b32 v108 offset:8976
    v_mfma_f32_16x16x32_bf16 v[116:119], v[72:75], a[180:183], v[116:119]
    ds_write_addtid_b32 v109 offset:9296
    v_mfma_f32_16x16x32_bf16 v[120:123], v[72:75], a[184:187], v[120:123]
    ds_write_addtid_b32 v110 offset:9616
    v_mfma_f32_16x16x32_bf16 v[124:127], v[72:75], a[188:191], v[124:127]
    ds_write_addtid_b32 v111 offset:9936
    s_waitcnt vmcnt(8)
    v_mfma_f32_16x16x32_bf16 v[112:115], v[76:79], a[192:195], v[112:115]
    v_mfma_f32_16x16x32_bf16 v[116:119], v[76:79], a[196:199], v[116:119]
    v_mfma_f32_16x16x32_bf16 v[120:123], v[76:79], a[200:203], v[120:123]
    v_mfma_f32_16x16x32_bf16 v[124:127], v[76:79], a[204:207], v[124:127]
    s_waitcnt vmcnt(7)
    v_mfma_f32_16x16x32_bf16 v[112:115], v[192:195], a[208:211], v[112:115]
    s_waitcnt lgkmcnt(0)
    s_barrier
    v_mfma_f32_16x16x32_bf16 v[116:119], v[192:195], a[212:215], v[116:119]
    ds_read_b128 v[16:19], v231 offset:0
    v_mfma_f32_16x16x32_bf16 v[120:123], v[192:195], a[216:219], v[120:123]
    ds_read_b128 v[20:23], v231 offset:24576
    v_mfma_f32_16x16x32_bf16 v[124:127], v[192:195], a[220:223], v[124:127]
    ds_read_b128 v[24:27], v232 offset:0
    s_waitcnt vmcnt(6)
    v_mfma_f32_16x16x32_bf16 v[128:131], v[196:199], a[112:115], v[128:131]
    ds_read_b128 v[28:31], v232 offset:24576
    v_mfma_f32_16x16x32_bf16 v[132:135], v[196:199], a[116:119], v[132:135]
    ds_read_b128 v[32:35], v231 offset:16
    v_mfma_f32_16x16x32_bf16 v[136:139], v[196:199], a[120:123], v[136:139]
    ds_read_b128 v[36:39], v231 offset:24592
    v_mfma_f32_16x16x32_bf16 v[140:143], v[196:199], a[124:127], v[140:143]
    ds_read_b128 v[40:43], v232 offset:16
    s_waitcnt vmcnt(5)
    v_mfma_f32_16x16x32_bf16 v[128:131], v[200:203], a[128:131], v[128:131]
    ds_read_b128 v[44:47], v232 offset:24592
    v_mfma_f32_16x16x32_bf16 v[132:135], v[200:203], a[132:135], v[132:135]
    s_waitcnt lgkmcnt(4)
    v_add_f32 v16, v16, v20
    v_add_f32 v17, v17, v21
    v_mfma_f32_16x16x32_bf16 v[136:139], v[200:203], a[136:139], v[136:139]
    ds_write_addtid_b32 v112 offset:10240
    v_add_f32 v18, v18, v22
    v_add_f32 v19, v19, v23
    v_mfma_f32_16x16x32_bf16 v[140:143], v[200:203], a[140:143], v[140:143]
    ds_write_addtid_b32 v113 offset:10560
    v_add_f32 v24, v24, v28
    v_add_f32 v25, v25, v29
    s_waitcnt vmcnt(4)
    v_mfma_f32_16x16x32_bf16 v[128:131], v[204:207], a[144:147], v[128:131]
    ds_write_addtid_b32 v114 offset:10880
    v_add_f32 v26, v26, v30
    v_add_f32 v27, v27, v31
    v_mfma_f32_16x16x32_bf16 v[132:135], v[204:207], a[148:151], v[132:135]
    ds_write_addtid_b32 v115 offset:11200
    v_add_f32 v16, v16, v24
    v_add_f32 v17, v17, v25
    v_mfma_f32_16x16x32_bf16 v[136:139], v[204:207], a[152:155], v[136:139]
    ds_write_addtid_b32 v116 offset:11536
    v_add_f32 v18, v18, v26
    v_add_f32 v19, v19, v27
    v_mfma_f32_16x16x32_bf16 v[140:143], v[204:207], a[156:159], v[140:143]
    ds_write_addtid_b32 v117 offset:11856
    v_cvt_pk_bf16_f32 v20, v16, v17
    v_cvt_pk_bf16_f32 v21, v18, v19
    s_waitcnt vmcnt(3)
    v_mfma_f32_16x16x32_bf16 v[128:131], v[144:147], a[160:163], v[128:131]
    s_waitcnt lgkmcnt(6)
    ds_write_addtid_b32 v118 offset:12176
    v_add_f32 v32, v32, v36
    v_add_f32 v33, v33, v37
    v_mfma_f32_16x16x32_bf16 v[132:135], v[144:147], a[164:167], v[132:135]
    ds_write_addtid_b32 v119 offset:12496
    v_add_f32 v34, v34, v38
    v_mfma_f32_16x16x32_bf16 v[136:139], v[144:147], a[168:171], v[136:139]
    ds_write_addtid_b32 v120 offset:12800
    v_add_f32 v35, v35, v39
    v_mfma_f32_16x16x32_bf16 v[140:143], v[144:147], a[172:175], v[140:143]
    ds_write_addtid_b32 v121 offset:13120
    v_add_f32 v40, v40, v44
    s_waitcnt vmcnt(2)
    v_mfma_f32_16x16x32_bf16 v[128:131], v[148:151], a[176:179], v[128:131]
    ds_write_addtid_b32 v122 offset:13440
    v_add_f32 v41, v41, v45
    v_mfma_f32_16x16x32_bf16 v[132:135], v[148:151], a[180:183], v[132:135]
    ds_write_addtid_b32 v123 offset:13760
    v_add_f32 v42, v42, v46
    v_mfma_f32_16x16x32_bf16 v[136:139], v[148:151], a[184:187], v[136:139]
    ds_write_addtid_b32 v124 offset:14096
    v_add_f32 v43, v43, v47
    v_mfma_f32_16x16x32_bf16 v[140:143], v[148:151], a[188:191], v[140:143]
    ds_write_addtid_b32 v125 offset:14416
    v_add_f32 v32, v32, v40
    s_waitcnt vmcnt(1)
    v_mfma_f32_16x16x32_bf16 v[128:131], v[152:155], a[192:195], v[128:131]
    ds_write_addtid_b32 v126 offset:14736
    v_add_f32 v33, v33, v41
    v_mfma_f32_16x16x32_bf16 v[132:135], v[152:155], a[196:199], v[132:135]
    ds_write_addtid_b32 v127 offset:15056
    v_add_f32 v34, v34, v42
    v_mfma_f32_16x16x32_bf16 v[136:139], v[152:155], a[200:203], v[136:139]
    v_add_f32 v35, v35, v43
    v_cvt_pk_bf16_f32 v22, v32, v33
    v_mfma_f32_16x16x32_bf16 v[140:143], v[152:155], a[204:207], v[140:143]
    v_cvt_pk_bf16_f32 v23, v34, v35
    s_waitcnt vmcnt(0)
    v_mfma_f32_16x16x32_bf16 v[128:131], v[156:159], a[208:211], v[128:131]
    buffer_store_dwordx4 v[20:23], v234, s[24:27], s3 offen sc1
    s_add_u32 s3, s3, 32768
    v_mfma_f32_16x16x32_bf16 v[132:135], v[156:159], a[212:215], v[132:135]
    v_mfma_f32_16x16x32_bf16 v[136:139], v[156:159], a[216:219], v[136:139]
    v_mfma_f32_16x16x32_bf16 v[140:143], v[156:159], a[220:223], v[140:143]
    s_nop 4
    ds_write_addtid_b32 v128 offset:15360
    ds_write_addtid_b32 v129 offset:15680
    ds_write_addtid_b32 v130 offset:16000
    ds_write_addtid_b32 v131 offset:16320
    ds_write_addtid_b32 v132 offset:16656
    ds_write_addtid_b32 v133 offset:16976
    ds_write_addtid_b32 v134 offset:17296
    ds_write_addtid_b32 v135 offset:17616
    ds_write_addtid_b32 v136 offset:17920
    ds_write_addtid_b32 v137 offset:18240
    ds_write_addtid_b32 v138 offset:18560
    ds_write_addtid_b32 v139 offset:18880
    ds_write_addtid_b32 v140 offset:19216
    ds_write_addtid_b32 v141 offset:19536
    ds_write_addtid_b32 v142 offset:19856
    ds_write_addtid_b32 v143 offset:20176
    s_waitcnt lgkmcnt(0)
    s_barrier
    ds_read_b128 v[48:51], v231 offset:10240
    ds_read_b128 v[52:55], v231 offset:34816
    ds_read_b128 v[56:59], v232 offset:10240
    ds_read_b128 v[60:63], v232 offset:34816
    ds_read_b128 v[64:67], v231 offset:10256
    ds_read_b128 v[68:71], v231 offset:34832
    ds_read_b128 v[72:75], v232 offset:10256
    ds_read_b128 v[76:79], v232 offset:34832
    s_waitcnt lgkmcnt(4)
    s_nop 0
    v_pk_add_f32 v[48:49], v[48:49], v[52:53]
    v_pk_add_f32 v[56:57], v[56:57], v[60:61]
    v_pk_add_f32 v[50:51], v[50:51], v[54:55]
    v_pk_add_f32 v[58:59], v[58:59], v[62:63]
    v_pk_add_f32 v[48:49], v[48:49], v[56:57]
    v_pk_add_f32 v[50:51], v[50:51], v[58:59]
    v_cvt_pk_bf16_f32 v52, v48, v49
    v_cvt_pk_bf16_f32 v53, v50, v51
    s_waitcnt lgkmcnt(0)
    s_nop 0
    v_pk_add_f32 v[64:65], v[64:65], v[68:69]
    v_pk_add_f32 v[72:73], v[72:73], v[76:77]
    v_pk_add_f32 v[66:67], v[66:67], v[70:71]
    v_pk_add_f32 v[74:75], v[74:75], v[78:79]
    v_pk_add_f32 v[64:65], v[64:65], v[72:73]
    v_pk_add_f32 v[66:67], v[66:67], v[74:75]
    v_cvt_pk_bf16_f32 v54, v64, v65
    v_cvt_pk_bf16_f32 v55, v66, v67
    buffer_store_dwordx4 v[52:55], v234, s[24:27], s3 offen sc1
END:
    s_endpgm
CLEAR:
    s_mov_b32 s32, s16
    s_and_b32 s33, s17, 0xffff
    s_mov_b32 s34, 15204352
    s_mov_b32 s35, 0x20000
    s_mov_b32 s36, s14
    s_and_b32 s37, s15, 0xffff
    s_mov_b32 s38, 256
    s_mov_b32 s39, 0x20000
    v_mov_b32 v16, 0
    v_mov_b32 v17, 0
    v_mov_b32 v18, 0
    v_mov_b32 v19, 0
    v_lshrrev_b32 v14, 3, v0
    v_lshlrev_b32 v14, 12, v14
    v_lshl_add_u32 v14, v4, 4, v14
    s_mov_b32 s23, 14680064
    buffer_store_dwordx4 v[16:19], v14, s[32:35], s23 offen sc1
    s_add_u32 s23, s23, 131072
    buffer_store_dwordx4 v[16:19], v14, s[32:35], s23 offen sc1
    s_add_u32 s23, s23, 131072
    buffer_store_dwordx4 v[16:19], v14, s[32:35], s23 offen sc1
    s_add_u32 s23, s23, 131072
    buffer_store_dwordx4 v[16:19], v14, s[32:35], s23 offen sc1
    s_add_u32 s23, s23, 131072
    s_waitcnt vmcnt(0)
    s_barrier
    v_mov_b32 v17, 1
    s_mov_b64 exec, 1
    buffer_store_dword v17, v16, s[36:39], 0 offen sc1
    s_mov_b64 exec, -1
    s_branch CLEARED
HELPER:
    s_mov_b32 s32, s16
    s_and_b32 s33, s17, 0xffff
    s_mov_b32 s34, 15204352
    s_mov_b32 s35, 0x20000
    s_mov_b32 s36, s10
    s_and_b32 s37, s11, 0xffff
    s_mov_b32 s38, 1835008
    s_mov_b32 s39, 0x20000
    v_lshlrev_b32 v221, 4, v2
    v_mov_b32 v6, 0x88884000
    v_lshlrev_b32 v7, 2, v3
    v_bfe_u32 v6, v6, v7, 4
    v_lshl_add_u32 v221, v6, 7, v221
    v_mov_b32 v240, 0
    v_lshlrev_b32 v6, 1, v5
    v_xor_b32 v6, v6, v4
    v_lshlrev_b32 v6, 4, v6
    v_lshl_add_u32 v6, v3, 10, v6
    s_lshl_b32 s23, s22, 7
    v_add_u32 v226, s23, v6
    v_add_u32 v227, 7168, v226
    v_add_u32 v228, 16384, v226
    v_add_u32 v229, 16384, v227
    v_lshrrev_b32 v6, 2, v2
    v_lshlrev_b32 v6, 7, v6
    v_and_b32 v7, 3, v3
    v_lshl_add_u32 v6, v7, 5, v6
    v_and_b32 v7, 3, v2
    v_lshl_add_u32 v6, v7, 3, v6
    v_add_u32 v244, s43, v6
    v_xor_b32 v245, 32, v244
    v_xor_b32 v246, 64, v244
    v_xor_b32 v247, 96, v244
    s_lshl_b32 s23, s21, 2
    s_add_u32 s23, s23, s18
    s_lshl_b32 s23, s23, 12
    s_add_u32 s23, s23, 14680064
    s_add_u32 s52, s16, s23
    s_addc_u32 s53, s17, 0
    s_mul_i32 s23, s18, 7
    s_and_b32 s57, s23, 1
    s_lshl_b32 s23, s23, 1
    s_sub_u32 s23, s23, s57
    s_lshl_b32 s4, s23, 15
    s_lshl_b32 s57, s57, 16
    s_add_u32 s57, s57, 0x8000
    s_add_u32 s5, s4, s57
    s_add_u32 s6, s4, 0x20000
    s_add_u32 s7, s5, 0x20000
    s_add_u32 s8, s6, 0x20000
    s_add_u32 s9, s7, 0x20000
    s_add_u32 s10, s8, 0x20000
    s_add_u32 s57, s22, s21
    s_mov_b32 s23, s4
    s_bitcmp1_b32 s57, 0
    s_cselect_b32 s4, s8, s4
    s_cselect_b32 s8, s5, s8
    s_cselect_b32 s5, s9, s5
    s_cselect_b32 s9, s6, s9
    s_cselect_b32 s6, s10, s6
    s_cselect_b32 s10, s7, s10
    s_cselect_b32 s7, s23, s7
    s_lshr_b32 s23, s21, 2
    s_mul_i32 s23, s23, 1835008
    s_and_b32 s57, s21, 3
    s_lshl_b32 s57, s57, 13
    s_add_u32 s23, s23, s57
    v_add_u32 v242, s23, v221
    v_add_u32 v243, 4096, v242
    v_lshrrev_b32 v6, 1, v4
    v_mul_u32_u24 v6, 1280, v6
    v_bfe_u32 v7, v4, 1, 1
    v_lshl_add_u32 v6, v7, 4, v6
    v_and_b32 v7, 1, v4
    v_lshl_add_u32 v6, v7, 5, v6
    v_lshrrev_b32 v7, 5, v2
    v_lshl_add_u32 v6, v7, 6, v6
    v_and_b32 v7, 3, v3
    v_mul_u32_u24 v7, 320, v7
    v_add_u32 v6, v6, v7
    s_lshr_b32 s23, s18, 1
    s_mul_i32 s23, s23, 5120
    s_and_b32 s57, s18, 1
    s_lshl_b32 s57, s57, 7
    s_add_u32 s23, s23, s57
    v_add_u32 v231, s23, v6
    v_add_u32 v232, 49152, v231
    v_lshlrev_b32 v6, 4, v4
    v_lshl_add_u32 v234, v3, 10, v6
    s_lshl_b32 s3, s21, 16
    s_lshl_b32 s23, s18, 13
    s_add_u32 s3, s3, s23
    s_lshl_b32 s23, s22, 7
    s_add_u32 s3, s3, s23
    s_add_u32 m0, s43, 0
    s_nop 0
    buffer_load_dwordx4 v226, s[36:39], s4 offen offset:0 lds
    buffer_load_dwordx4 v227, s[36:39], s4 offen offset:1024 lds
    s_add_u32 m0, s43, 2048
    s_nop 0
    buffer_load_dwordx4 v228, s[36:39], s4 offen offset:0 lds
    buffer_load_dwordx4 v229, s[36:39], s4 offen offset:1024 lds
    s_add_u32 m0, s43, 4096
    s_nop 0
    buffer_load_dwordx4 v226, s[36:39], s5 offen offset:0 lds
    buffer_load_dwordx4 v227, s[36:39], s5 offen offset:1024 lds
    s_add_u32 m0, s43, 6144
    s_nop 0
    buffer_load_dwordx4 v228, s[36:39], s5 offen offset:0 lds
    buffer_load_dwordx4 v229, s[36:39], s5 offen offset:1024 lds
    s_add_u32 m0, s43, 8192
    s_nop 0
    buffer_load_dwordx4 v226, s[36:39], s6 offen offset:0 lds
    buffer_load_dwordx4 v227, s[36:39], s6 offen offset:1024 lds
    s_add_u32 m0, s43, 10240
    s_nop 0
    buffer_load_dwordx4 v228, s[36:39], s6 offen offset:0 lds
    buffer_load_dwordx4 v229, s[36:39], s6 offen offset:1024 lds
    s_add_u32 m0, s43, 12288
    s_nop 0
    buffer_load_dwordx4 v226, s[36:39], s7 offen offset:0 lds
    buffer_load_dwordx4 v227, s[36:39], s7 offen offset:1024 lds
    s_add_u32 m0, s43, 14336
    s_nop 0
    buffer_load_dwordx4 v228, s[36:39], s7 offen offset:0 lds
    buffer_load_dwordx4 v229, s[36:39], s7 offen offset:1024 lds
    s_add_u32 m0, s43, 16384
    s_nop 0
    buffer_load_dwordx4 v226, s[36:39], s8 offen offset:0 lds
    buffer_load_dwordx4 v227, s[36:39], s8 offen offset:1024 lds
    s_add_u32 m0, s43, 18432
    s_nop 0
    buffer_load_dwordx4 v228, s[36:39], s8 offen offset:0 lds
    buffer_load_dwordx4 v229, s[36:39], s8 offen offset:1024 lds
    s_add_u32 m0, s43, 20480
    s_nop 0
    buffer_load_dwordx4 v226, s[36:39], s9 offen offset:0 lds
    buffer_load_dwordx4 v227, s[36:39], s9 offen offset:1024 lds
    s_waitcnt vmcnt(20)
    ds_read_b64_tr_b16 a[0:1], v244 offset:0
    ds_read_b64_tr_b16 a[4:5], v245 offset:0
    ds_read_b64_tr_b16 a[8:9], v246 offset:0
    ds_read_b64_tr_b16 a[12:13], v247 offset:0
    s_add_u32 m0, s43, 22528
    s_nop 0
    buffer_load_dwordx4 v228, s[36:39], s9 offen offset:0 lds
    buffer_load_dwordx4 v229, s[36:39], s9 offen offset:1024 lds
    s_waitcnt vmcnt(20)
    ds_read_b64_tr_b16 a[2:3], v244 offset:2048
    ds_read_b64_tr_b16 a[6:7], v245 offset:2048
    ds_read_b64_tr_b16 a[10:11], v246 offset:2048
    ds_read_b64_tr_b16 a[14:15], v247 offset:2048
    s_waitcnt lgkmcnt(4)
    s_add_u32 m0, s43, 0
    s_nop 0
    buffer_load_dwordx4 v226, s[36:39], s10 offen offset:0 lds
    v_add_u32 v226, 0x10000, v226
    buffer_load_dwordx4 v227, s[36:39], s10 offen offset:1024 lds
    s_waitcnt vmcnt(20)
    ds_read_b64_tr_b16 a[16:17], v244 offset:4096
    ds_read_b64_tr_b16 a[20:21], v245 offset:4096
    ds_read_b64_tr_b16 a[24:25], v246 offset:4096
    ds_read_b64_tr_b16 a[28:29], v247 offset:4096
    s_waitcnt lgkmcnt(4)
    v_add_u32 v227, 0x10000, v227
    s_add_u32 m0, s43, 2048
    s_nop 0
    buffer_load_dwordx4 v228, s[36:39], s10 offen offset:0 lds
    v_add_u32 v228, 0x10000, v228
    buffer_load_dwordx4 v229, s[36:39], s10 offen offset:1024 lds
    s_waitcnt vmcnt(20)
    ds_read_b64_tr_b16 a[18:19], v244 offset:6144
    ds_read_b64_tr_b16 a[22:23], v245 offset:6144
    ds_read_b64_tr_b16 a[26:27], v246 offset:6144
    ds_read_b64_tr_b16 a[30:31], v247 offset:6144
    s_waitcnt lgkmcnt(4)
    v_add_u32 v229, 0x10000, v229
    s_add_u32 m0, s43, 4096
    s_nop 0
    buffer_load_dwordx4 v226, s[36:39], s4 offen offset:0 lds
    buffer_load_dwordx4 v227, s[36:39], s4 offen offset:1024 lds
    s_waitcnt vmcnt(20)
    ds_read_b64_tr_b16 a[32:33], v244 offset:8192
    ds_read_b64_tr_b16 a[36:37], v245 offset:8192
    ds_read_b64_tr_b16 a[40:41], v246 offset:8192
    ds_read_b64_tr_b16 a[44:45], v247 offset:8192
    s_waitcnt lgkmcnt(4)
    s_add_u32 m0, s43, 6144
    s_nop 0
    buffer_load_dwordx4 v228, s[36:39], s4 offen offset:0 lds
    buffer_load_dwordx4 v229, s[36:39], s4 offen offset:1024 lds
    s_waitcnt vmcnt(20)
    ds_read_b64_tr_b16 a[34:35], v244 offset:10240
    ds_read_b64_tr_b16 a[38:39], v245 offset:10240
    ds_read_b64_tr_b16 a[42:43], v246 offset:10240
    ds_read_b64_tr_b16 a[46:47], v247 offset:10240
    s_waitcnt lgkmcnt(4)
    s_add_u32 m0, s43, 8192
    s_nop 0
    buffer_load_dwordx4 v226, s[36:39], s5 offen offset:0 lds
    buffer_load_dwordx4 v227, s[36:39], s5 offen offset:1024 lds
    s_waitcnt vmcnt(20)
    ds_read_b64_tr_b16 a[48:49], v244 offset:12288
    ds_read_b64_tr_b16 a[52:53], v245 offset:12288
    ds_read_b64_tr_b16 a[56:57], v246 offset:12288
    ds_read_b64_tr_b16 a[60:61], v247 offset:12288
    s_waitcnt lgkmcnt(4)
    s_add_u32 m0, s43, 10240
    s_nop 0
    buffer_load_dwordx4 v228, s[36:39], s5 offen offset:0 lds
    buffer_load_dwordx4 v229, s[36:39], s5 offen offset:1024 lds
    s_waitcnt vmcnt(20)
    ds_read_b64_tr_b16 a[50:51], v244 offset:14336
    ds_read_b64_tr_b16 a[54:55], v245 offset:14336
    ds_read_b64_tr_b16 a[58:59], v246 offset:14336
    ds_read_b64_tr_b16 a[62:63], v247 offset:14336
    s_waitcnt lgkmcnt(4)
    s_add_u32 m0, s43, 12288
    s_nop 0
    buffer_load_dwordx4 v226, s[36:39], s6 offen offset:0 lds
    buffer_load_dwordx4 v227, s[36:39], s6 offen offset:1024 lds
    s_waitcnt vmcnt(20)
    ds_read_b64_tr_b16 a[64:65], v244 offset:16384
    ds_read_b64_tr_b16 a[68:69], v245 offset:16384
    ds_read_b64_tr_b16 a[72:73], v246 offset:16384
    ds_read_b64_tr_b16 a[76:77], v247 offset:16384
    s_waitcnt lgkmcnt(4)
    s_add_u32 m0, s43, 14336
    s_nop 0
    buffer_load_dwordx4 v228, s[36:39], s6 offen offset:0 lds
    buffer_load_dwordx4 v229, s[36:39], s6 offen offset:1024 lds
    s_waitcnt vmcnt(20)
    ds_read_b64_tr_b16 a[66:67], v244 offset:18432
    ds_read_b64_tr_b16 a[70:71], v245 offset:18432
    ds_read_b64_tr_b16 a[74:75], v246 offset:18432
    ds_read_b64_tr_b16 a[78:79], v247 offset:18432
    s_waitcnt lgkmcnt(4)
    s_add_u32 m0, s43, 16384
    s_nop 0
    buffer_load_dwordx4 v226, s[36:39], s7 offen offset:0 lds
    buffer_load_dwordx4 v227, s[36:39], s7 offen offset:1024 lds
    s_waitcnt vmcnt(20)
    ds_read_b64_tr_b16 a[80:81], v244 offset:20480
    ds_read_b64_tr_b16 a[84:85], v245 offset:20480
    ds_read_b64_tr_b16 a[88:89], v246 offset:20480
    ds_read_b64_tr_b16 a[92:93], v247 offset:20480
    s_waitcnt lgkmcnt(4)
    s_add_u32 m0, s43, 18432
    s_nop 0
    buffer_load_dwordx4 v228, s[36:39], s7 offen offset:0 lds
    buffer_load_dwordx4 v229, s[36:39], s7 offen offset:1024 lds
    s_waitcnt vmcnt(20)
    ds_read_b64_tr_b16 a[82:83], v244 offset:22528
    ds_read_b64_tr_b16 a[86:87], v245 offset:22528
    ds_read_b64_tr_b16 a[90:91], v246 offset:22528
    ds_read_b64_tr_b16 a[94:95], v247 offset:22528
    s_waitcnt vmcnt(18)
    ds_read_b64_tr_b16 a[96:97], v244 offset:0
    ds_read_b64_tr_b16 a[100:101], v245 offset:0
    ds_read_b64_tr_b16 a[104:105], v246 offset:0
    ds_read_b64_tr_b16 a[108:109], v247 offset:0
    s_waitcnt vmcnt(16)
    ds_read_b64_tr_b16 a[98:99], v244 offset:2048
    ds_read_b64_tr_b16 a[102:103], v245 offset:2048
    ds_read_b64_tr_b16 a[106:107], v246 offset:2048
    ds_read_b64_tr_b16 a[110:111], v247 offset:2048
    s_waitcnt vmcnt(14)
    ds_read_b64_tr_b16 a[112:113], v244 offset:4096
    ds_read_b64_tr_b16 a[116:117], v245 offset:4096
    ds_read_b64_tr_b16 a[120:121], v246 offset:4096
    ds_read_b64_tr_b16 a[124:125], v247 offset:4096
    s_waitcnt vmcnt(12)
    ds_read_b64_tr_b16 a[114:115], v244 offset:6144
    ds_read_b64_tr_b16 a[118:119], v245 offset:6144
    ds_read_b64_tr_b16 a[122:123], v246 offset:6144
    ds_read_b64_tr_b16 a[126:127], v247 offset:6144
    s_waitcnt vmcnt(10)
    ds_read_b64_tr_b16 a[128:129], v244 offset:8192
    ds_read_b64_tr_b16 a[132:133], v245 offset:8192
    ds_read_b64_tr_b16 a[136:137], v246 offset:8192
    ds_read_b64_tr_b16 a[140:141], v247 offset:8192
    s_waitcnt vmcnt(8)
    ds_read_b64_tr_b16 a[130:131], v244 offset:10240
    ds_read_b64_tr_b16 a[134:135], v245 offset:10240
    ds_read_b64_tr_b16 a[138:139], v246 offset:10240
    ds_read_b64_tr_b16 a[142:143], v247 offset:10240
    s_waitcnt vmcnt(6)
    ds_read_b64_tr_b16 a[144:145], v244 offset:12288
    ds_read_b64_tr_b16 a[148:149], v245 offset:12288
    ds_read_b64_tr_b16 a[152:153], v246 offset:12288
    ds_read_b64_tr_b16 a[156:157], v247 offset:12288
    s_waitcnt vmcnt(4)
    ds_read_b64_tr_b16 a[146:147], v244 offset:14336
    ds_read_b64_tr_b16 a[150:151], v245 offset:14336
    ds_read_b64_tr_b16 a[154:155], v246 offset:14336
    ds_read_b64_tr_b16 a[158:159], v247 offset:14336
    s_waitcnt vmcnt(2)
    ds_read_b64_tr_b16 a[160:161], v244 offset:16384
    ds_read_b64_tr_b16 a[164:165], v245 offset:16384
    ds_read_b64_tr_b16 a[168:169], v246 offset:16384
    ds_read_b64_tr_b16 a[172:173], v247 offset:16384
    s_waitcnt vmcnt(0)
    ds_read_b64_tr_b16 a[162:163], v244 offset:18432
    ds_read_b64_tr_b16 a[166:167], v245 offset:18432
    ds_read_b64_tr_b16 a[170:171], v246 offset:18432
    ds_read_b64_tr_b16 a[174:175], v247 offset:18432
    s_waitcnt lgkmcnt(0)
    s_add_u32 m0, s43, 12288
    s_nop 0
    buffer_load_dwordx4 v226, s[36:39], s8 offen offset:0 lds
    buffer_load_dwordx4 v227, s[36:39], s8 offen offset:1024 lds
    s_add_u32 m0, s43, 14336
    s_nop 0
    buffer_load_dwordx4 v228, s[36:39], s8 offen offset:0 lds
    buffer_load_dwordx4 v229, s[36:39], s8 offen offset:1024 lds
    s_add_u32 m0, s43, 16384
    s_nop 0
    buffer_load_dwordx4 v226, s[36:39], s9 offen offset:0 lds
    buffer_load_dwordx4 v227, s[36:39], s9 offen offset:1024 lds
    s_add_u32 m0, s43, 18432
    s_nop 0
    buffer_load_dwordx4 v228, s[36:39], s9 offen offset:0 lds
    buffer_load_dwordx4 v229, s[36:39], s9 offen offset:1024 lds
    s_add_u32 m0, s43, 20480
    s_nop 0
    buffer_load_dwordx4 v226, s[36:39], s10 offen offset:0 lds
    buffer_load_dwordx4 v227, s[36:39], s10 offen offset:1024 lds
    s_add_u32 m0, s43, 22528
    s_nop 0
    buffer_load_dwordx4 v228, s[36:39], s10 offen offset:0 lds
    buffer_load_dwordx4 v229, s[36:39], s10 offen offset:1024 lds
    s_mov_b32 s11, 1
    s_mov_b32 s51, 0
EP_SPIN2:
    global_load_dword v235, v240, s[14:15] sc1
    s_add_u32 s51, s51, 1
    s_waitcnt vmcnt(0)
    s_cmp_gt_u32 s51, 200000
    s_cbranch_scc1 EP_SPIN2_X
    v_readfirstlane_b32 s56, v235
    s_cmp_lg_u32 s56, 1
    s_cbranch_scc1 EP_SPIN2
EP_SPIN2_X:
    s_mov_b32 s51, 0
HPOLL:
    s_load_dword s54, s[52:53], 0x0 glc
    s_add_u32 s51, s51, 1
    s_waitcnt lgkmcnt(0)
    s_cmp_gt_u32 s51, 200000
    s_cbranch_scc1 HPOLL_X
    s_bfe_u32 s23, s54, 0x80000
    s_cmp_lg_u32 s23, 7
    s_cbranch_scc1 HPOLL
HPOLL_X:
    buffer_load_dwordx4 v[16:19], v242, s[32:35], s4 offen offset:0 sc1
    buffer_load_dwordx4 v[20:23], v242, s[32:35], s4 offen offset:2048 sc1
    buffer_load_dwordx4 v[24:27], v243, s[32:35], s4 offen offset:0 sc1
    buffer_load_dwordx4 v[28:31], v243, s[32:35], s4 offen offset:2048 sc1
    buffer_load_dwordx4 v[32:35], v242, s[32:35], s5 offen offset:0 sc1
    buffer_load_dwordx4 v[36:39], v242, s[32:35], s5 offen offset:2048 sc1
    buffer_load_dwordx4 v[40:43], v243, s[32:35], s5 offen offset:0 sc1
    buffer_load_dwordx4 v[44:47], v243, s[32:35], s5 offen offset:2048 sc1
    buffer_load_dwordx4 v[48:51], v242, s[32:35], s6 offen offset:0 sc1
    buffer_load_dwordx4 v[52:55], v242, s[32:35], s6 offen offset:2048 sc1
    buffer_load_dwordx4 v[56:59], v243, s[32:35], s6 offen offset:0 sc1
    buffer_load_dwordx4 v[60:63], v243, s[32:35], s6 offen offset:2048 sc1
    buffer_load_dwordx4 v[64:67], v242, s[32:35], s7 offen offset:0 sc1
    buffer_load_dwordx4 v[68:71], v242, s[32:35], s7 offen offset:2048 sc1
    s_waitcnt vmcnt(0)
    s_branch JOIN
CODE_END:
.section .rodata,"a"
.p2align 6
.amdhsa_kernel standalone__glu_gated_geglu__prompt_kernel
  .amdhsa_next_free_vgpr 512
  .amdhsa_next_free_sgpr 102
  .amdhsa_accum_offset 256
  .amdhsa_group_segment_fixed_size 0
  .amdhsa_kernarg_size 56
  .amdhsa_user_sgpr_count 2
  .amdhsa_user_sgpr_kernarg_segment_ptr 1
  .amdhsa_system_sgpr_workgroup_id_x 1
  .amdhsa_float_denorm_mode_32 3
.end_amdhsa_kernel
```
